```python
import torch

def _softmax(x, axis=-1):
    return torch.softmax(x, dim=axis)

def _gelu(x):
    return torch.nn.functional.gelu(x, approximate='tanh')

def _silu(x):
    return torch.nn.functional.silu(x)

def _sigmoid(x):
    return torch.sigmoid(x)

def _layernorm(x, axis=-1, eps=1e-05):
    m = x.mean(dim=axis, keepdim=True)
    v = x.var(dim=axis, keepdim=True, unbiased=False)
    return (x - m) / torch.sqrt(v + eps)

def _scatter_add(tgt, idx, src, axis=0):
    return tgt.clone().index_add_(axis, idx, src)

def _segment_sum(src, seg, n):
    out = torch.zeros((n,) + src.shape[1:], dtype=src.dtype)
    return out.index_add_(0, seg, src)

def _pad(x, pw):
    flat = tuple((v for pair in reversed(pw) for v in pair))
    return torch.nn.functional.pad(x, flat)
kernel_name = 'standalone__video_timesformer__vision'

def setup_inputs():

    _w = lambda a: (lambda t: t.to(torch.bfloat16) if t.is_floating_point() else t)(torch.as_tensor(a))
    T = 8
    p = 14
    HW = 512 // p * p
    N = (HW // p) ** 2
    C = 192
    return {'x': _w((lambda *s: torch.randn(*s, dtype=torch.bfloat16) * 0.1)(1, T, N, C)), 'wqkv_t': _w((lambda *s: torch.randn(*s, dtype=torch.bfloat16) * 0.1)(C, 3 * C)), 'wo_t': _w((lambda *s: torch.randn(*s, dtype=torch.bfloat16) * 0.1)(C, C)), 'wqkv_s': _w((lambda *s: torch.randn(*s, dtype=torch.bfloat16) * 0.1)(C, 3 * C)), 'wo_s': _w((lambda *s: torch.randn(*s, dtype=torch.bfloat16) * 0.8)(C, C))}

def reference(x, wqkv_t, wo_t, wqkv_s, wo_s):
    B, T, N, C = x.shape
    scale = C ** (-0.5)
    xt = (lambda x, *d: x.permute(*d))(x, 0, 2, 1, 3).reshape(B * N, T, C)
    h = _layernorm(xt, axis=-1)
    qkv = h @ wqkv_t
    q, k, v = (qkv[..., :C].clone(), qkv[..., C:2 * C].clone(), qkv[..., 2 * C:].clone())
    a = _softmax(torch.einsum('btc,bsc->bts', q, k) * scale, axis=-1)
    xt = xt + torch.einsum('bts,bsc->btc', a, v) @ wo_t
    x1 = (lambda x, *d: x.permute(*d))(xt.reshape(B, N, T, C), 0, 2, 1, 3)
    xs = x1.reshape(B * T, N, C)
    h = _layernorm(xs, axis=-1)
    qkv = h @ wqkv_s
    q, k, v = (qkv[..., :C].clone(), qkv[..., C:2 * C].clone(), qkv[..., 2 * C:].clone())
    a = _softmax(torch.einsum('bnc,bmc->bnm', q, k) * scale, axis=-1)
    xs = xs + torch.einsum('bnm,bmc->bnc', a, v) @ wo_s
    return xs.reshape(B, T, N, C)
```

```asm
; @launch kernel=standalone__video_timesformer__vision_kernel grid=(252,1,1) block=(256,1,1) lds=162816
; @launch kernel=standalone__video_timesformer__vision_b_kernel grid=(216,1,1) block=(256,1,1) lds=162560
.amdgcn_target "amdgcn-amd-amdhsa--gfx950"
.text
.globl standalone__video_timesformer__vision_kernel
.p2align 8
.type standalone__video_timesformer__vision_kernel,@function
standalone__video_timesformer__vision_kernel:
LA_start:
  s_cmp_ge_u32 s2, 252
  s_cbranch_scc1 LA_end
  s_cmp_lt_u32 s2, 36
  s_cbranch_scc1 LA_spare
  s_cmp_ge_u32 s2, 44
  s_cbranch_scc1 LA_nocpf
  s_getpc_b64 s[44:45]
LA_pc0:
  s_sub_u32 s44, s44, LA_pc0-LA_start
  s_subb_u32 s45, s45, 0
  v_lshlrev_b32 v4, 7, v0
  v_add_u32 v5, 32768, v4
  v_min_u32 v4, LB_end-LA_start-4, v4
  v_min_u32 v5, LB_end-LA_start-4, v5
  global_load_dword v210, v4, s[44:45]
  global_load_dword v211, v5, s[44:45]
LA_nocpf:
  s_load_dwordx2 s[8:9], s[0:1], 0
  s_load_dwordx2 s[12:13], s[0:1], 8
  s_load_dwordx2 s[20:21], s[0:1], 56
  s_load_dwordx2 s[52:53], s[0:1], 48
  v_lshrrev_b32 v4, 6, v0
  v_and_b32 v1, 63, v0
  v_readfirstlane_b32 s24, v4
  v_lshrrev_b32 v4, 3, v1
  v_and_b32 v5, 7, v1
  v_xor_b32 v5, v5, v4
  v_mul_u32_u24 v22, 497664, v4
  v_lshl_add_u32 v22, v5, 4, v22
  s_sub_u32 s43, s2, 36
  s_mul_i32 s25, s43, 6
  s_mov_b32 s10, 3981312
  s_mov_b32 s11, 0x00020000
  s_mov_b32 s14, 221184
  s_mov_b32 s15, 0x00020000
  s_mov_b32 s54, 256
  s_mov_b32 s55, 0x00020000
  s_mov_b32 s22, 16777216
  s_mov_b32 s23, 0x00020000
  s_mul_i32 s28, s25, 384
  s_add_u32 s26, s24, 0
  s_lshl_b32 s27, s26, 10
  s_add_u32 m0, s27, 141312
  s_lshl_b32 s26, s26, 7
  s_add_u32 s26, s26, s28
  s_waitcnt lgkmcnt(0)
  buffer_load_dwordx4 v22, s[8:11], s26 offen lds
  s_add_u32 s26, s24, 4
  s_lshl_b32 s27, s26, 10
  s_add_u32 m0, s27, 141312
  s_lshl_b32 s26, s26, 7
  s_add_u32 s26, s26, s28
  buffer_load_dwordx4 v22, s[8:11], s26 offen lds
  s_add_u32 s26, s24, 8
  s_lshl_b32 s27, s26, 10
  s_add_u32 m0, s27, 141312
  s_lshl_b32 s26, s26, 7
  s_add_u32 s26, s26, s28
  buffer_load_dwordx4 v22, s[8:11], s26 offen lds
  s_add_u32 s26, s24, 12
  s_lshl_b32 s27, s26, 10
  s_add_u32 m0, s27, 141312
  s_lshl_b32 s26, s26, 7
  s_add_u32 s26, s26, s28
  buffer_load_dwordx4 v22, s[8:11], s26 offen lds
  s_add_u32 s26, s24, 16
  s_min_u32 s26, s26, 17
  s_lshl_b32 s27, s26, 10
  s_add_u32 m0, s27, 141312
  s_lshl_b32 s26, s26, 7
  s_add_u32 s26, s26, s28
  buffer_load_dwordx4 v22, s[8:11], s26 offen lds
  s_lshr_b32 s26, s43, 3
  s_mul_i32 s26, s26, 12288
  v_lshlrev_b32 v5, 7, v0
  v_add_u32 v5, s26, v5
  v_cmp_gt_u32 vcc, 96, v0
  v_mov_b32 v6, 0x7ffffff0
  v_lshrrev_b32 v2, 4, v1
  v_and_b32 v3, 15, v1
  v_cndmask_b32 v5, v6, v5, vcc
  buffer_load_dword v29, v5, s[12:15], 0 offen
  v_lshrrev_b32 v4, 3, v1
  v_bfe_u32 v7, v1, 4, 2
  v_lshlrev_b32 v7, 1, v7
  v_and_b32 v8, 7, v1
  v_xor_b32 v7, v7, v8
  s_lshl_b32 s26, s24, 3
  v_add_u32 v4, s26, v4
  v_mul_u32_u24 v9, 1152, v4
  v_lshl_add_u32 v9, v7, 4, v9
  s_mul_i32 s29, s24, 3072
  s_mov_b32 s39, 0
  s_add_u32 m0, s29, 0
  s_nop 0
  buffer_load_dwordx4 v9, s[12:15], s39 offen offset:0 lds
  s_add_u32 m0, s29, 896
  s_nop 0
  buffer_load_dwordx4 v9, s[12:15], s39 offen offset:128 lds
  s_add_u32 m0, s29, 1792
  s_nop 0
  buffer_load_dwordx4 v9, s[12:15], s39 offen offset:256 lds
  s_mul_i32 s27, s24, 12
  v_add_u32 v4, s27, v2
  v_add_u32 v4, 0, v4
  v_and_b32 v5, 7, v4
  v_lshrrev_b32 v6, 1, v3
  v_xor_b32 v6, v6, v5
  v_lshlrev_b32 v6, 4, v6
  v_lshl_add_u32 v6, v5, 7, v6
  v_and_b32 v5, 1, v3
  v_lshl_add_u32 v6, v5, 3, v6
  v_lshrrev_b32 v5, 3, v4
  v_mul_u32_u24 v5, 3072, v5
  v_add_u32 v6, v6, v5
  v_add_u32 v23, 141312, v6
  v_lshrrev_b32 v6, 4, v4
  v_mul_u32_u24 v6, 6, v6
  v_lshrrev_b32 v8, 3, v3
  v_add_u32 v6, v6, v8
  v_lshlrev_b32 v6, 10, v6
  v_mul_u32_u24 v8, 12, v8
  v_and_b32 v7, 15, v4
  v_xor_b32 v7, v7, v8
  v_and_b32 v8, 3, v3
  v_xor_b32 v7, v7, v8
  v_lshl_add_u32 v7, v8, 4, v7
  v_lshl_add_u32 v6, v7, 4, v6
  v_bfe_u32 v8, v3, 2, 1
  v_lshl_add_u32 v6, v8, 3, v6
  v_add_u32 v26, 122880, v6
  v_add_u32 v4, s27, v2
  v_add_u32 v4, 4, v4
  v_and_b32 v5, 7, v4
  v_lshrrev_b32 v6, 1, v3
  v_xor_b32 v6, v6, v5
  v_lshlrev_b32 v6, 4, v6
  v_lshl_add_u32 v6, v5, 7, v6
  v_and_b32 v5, 1, v3
  v_lshl_add_u32 v6, v5, 3, v6
  v_lshrrev_b32 v5, 3, v4
  v_mul_u32_u24 v5, 3072, v5
  v_add_u32 v6, v6, v5
  v_add_u32 v24, 141312, v6
  v_lshrrev_b32 v6, 4, v4
  v_mul_u32_u24 v6, 6, v6
  v_lshrrev_b32 v8, 3, v3
  v_add_u32 v6, v6, v8
  v_lshlrev_b32 v6, 10, v6
  v_mul_u32_u24 v8, 12, v8
  v_and_b32 v7, 15, v4
  v_xor_b32 v7, v7, v8
  v_and_b32 v8, 3, v3
  v_xor_b32 v7, v7, v8
  v_lshl_add_u32 v7, v8, 4, v7
  v_lshl_add_u32 v6, v7, 4, v6
  v_bfe_u32 v8, v3, 2, 1
  v_lshl_add_u32 v6, v8, 3, v6
  v_add_u32 v27, 122880, v6
  v_add_u32 v4, s27, v2
  v_add_u32 v4, 8, v4
  v_and_b32 v5, 7, v4
  v_lshrrev_b32 v6, 1, v3
  v_xor_b32 v6, v6, v5
  v_lshlrev_b32 v6, 4, v6
  v_lshl_add_u32 v6, v5, 7, v6
  v_and_b32 v5, 1, v3
  v_lshl_add_u32 v6, v5, 3, v6
  v_lshrrev_b32 v5, 3, v4
  v_mul_u32_u24 v5, 3072, v5
  v_add_u32 v6, v6, v5
  v_add_u32 v25, 141312, v6
  v_lshrrev_b32 v6, 4, v4
  v_mul_u32_u24 v6, 6, v6
  v_lshrrev_b32 v8, 3, v3
  v_add_u32 v6, v6, v8
  v_lshlrev_b32 v6, 10, v6
  v_mul_u32_u24 v8, 12, v8
  v_and_b32 v7, 15, v4
  v_xor_b32 v7, v7, v8
  v_and_b32 v8, 3, v3
  v_xor_b32 v7, v7, v8
  v_lshl_add_u32 v7, v8, 4, v7
  v_lshl_add_u32 v6, v7, 4, v6
  v_bfe_u32 v8, v3, 2, 1
  v_lshl_add_u32 v6, v8, 3, v6
  v_add_u32 v28, 122880, v6
  v_lshrrev_b32 v4, 1, v2
  v_mul_u32_u24 v4, 3072, v4
  v_and_b32 v5, 1, v2
  v_lshlrev_b32 v5, 2, v5
  v_lshrrev_b32 v6, 2, v3
  v_add_u32 v5, v5, v6
  v_lshl_add_u32 v4, v5, 7, v4
  v_bfe_u32 v5, v5, 1, 2
  v_lshlrev_b32 v5, 1, v5
  v_bfe_u32 v6, v3, 1, 1
  v_xor_b32 v5, v5, v6
  v_and_b32 v6, 1, v3
  v_lshl_add_u32 v4, v6, 3, v4
  s_mul_i32 s26, s24, 3
  s_add_u32 s26, s26, 0
  s_and_b32 s27, s26, 3
  s_lshl_b32 s27, s27, 1
  s_lshr_b32 s26, s26, 2
  s_lshl_b32 s26, s26, 10
  v_xor_b32 v6, s27, v5
  v_lshl_add_u32 v6, v6, 4, v4
  v_add_u32 v11, s26, v6
  v_add_u32 v14, 49152, v11
  v_add_u32 v17, 98304, v11
  s_mul_i32 s26, s24, 3
  s_add_u32 s26, s26, 1
  s_and_b32 s27, s26, 3
  s_lshl_b32 s27, s27, 1
  s_lshr_b32 s26, s26, 2
  s_lshl_b32 s26, s26, 10
  v_xor_b32 v6, s27, v5
  v_lshl_add_u32 v6, v6, 4, v4
  v_add_u32 v12, s26, v6
  v_add_u32 v15, 49152, v12
  v_add_u32 v18, 98304, v12
  s_mul_i32 s26, s24, 3
  s_add_u32 s26, s26, 2
  s_and_b32 s27, s26, 3
  s_lshl_b32 s27, s27, 1
  s_lshr_b32 s26, s26, 2
  s_lshl_b32 s26, s26, 10
  v_xor_b32 v6, s27, v5
  v_lshl_add_u32 v6, v6, 4, v4
  v_add_u32 v13, s26, v6
  v_add_u32 v16, 49152, v13
  v_add_u32 v19, 98304, v13
  v_xor_b32 v4, v3, v2
  v_lshl_add_u32 v5, v2, 4, v4
  v_lshlrev_b32 v20, 4, v5
  v_add_u32 v20, 122880, v20
  v_xor_b32 v21, 192, v20
  s_mul_i32 s26, s24, 3
  s_add_u32 s26, s26, 0
  s_lshr_b32 s27, s26, 1
  s_and_b32 s26, s26, 1
  s_lshl_b32 s26, s26, 3
  s_and_b32 s28, s27, 1
  s_mul_i32 s28, s28, 192
  s_lshl_b32 s27, s27, 10
  s_add_u32 s26, s26, s27
  v_xor_b32 v33, s28, v20
  v_add_u32 v33, s26, v33
  s_mul_i32 s26, s24, 3
  s_add_u32 s26, s26, 1
  s_lshr_b32 s27, s26, 1
  s_and_b32 s26, s26, 1
  s_lshl_b32 s26, s26, 3
  s_and_b32 s28, s27, 1
  s_mul_i32 s28, s28, 192
  s_lshl_b32 s27, s27, 10
  s_add_u32 s26, s26, s27
  v_xor_b32 v34, s28, v20
  v_add_u32 v34, s26, v34
  s_mul_i32 s26, s24, 3
  s_add_u32 s26, s26, 2
  s_lshr_b32 s27, s26, 1
  s_and_b32 s26, s26, 1
  s_lshl_b32 s26, s26, 3
  s_and_b32 s28, s27, 1
  s_mul_i32 s28, s28, 192
  s_lshl_b32 s27, s27, 10
  s_add_u32 s26, s26, s27
  v_xor_b32 v35, s28, v20
  v_add_u32 v35, s26, v35
  s_mul_i32 s26, s24, 3072
  s_add_u32 s26, s26, 122880
  v_lshlrev_b32 v36, 4, v1
  v_add_u32 v37, 122880, v36
  v_add_u32 v36, s26, v36
  s_mov_b32 s30, 1037384597
  s_mov_b32 s38, 1001040555
  v_lshrrev_b32 v4, 5, v1
  v_bfe_u32 v5, v1, 3, 1
  v_cmp_eq_u32 s[32:33], v4, v5
  v_lshrrev_b32 v4, 1, v2
  v_mul_u32_u24 v4, 48, v4
  v_add_u32 v4, v4, v3
  v_and_b32 v5, 1, v2
  v_lshl_add_u32 v5, v5, 4, v4
  s_lshl_b32 s26, s24, 2
  s_add_u32 s26, s26, 159744
  v_lshlrev_b32 v5, 4, v5
  v_add_u32 v38, s26, v5
  v_add_u32 v4, 32, v4
  v_lshlrev_b32 v4, 4, v4
  v_add_u32 v39, s26, v4
  v_lshlrev_b32 v40, 4, v3
  v_add_u32 v40, 159744, v40
  s_mul_i32 s26, s24, 6
  s_add_u32 s26, s26, 0
  v_lshrrev_b32 v4, 1, v2
  v_add_u32 v4, s26, v4
  v_and_b32 v5, 7, v4
  v_lshrrev_b32 v4, 3, v4
  v_and_b32 v6, 7, v3
  v_xor_b32 v5, v5, v6
  v_lshlrev_b32 v5, 4, v5
  v_lshl_add_u32 v5, v6, 7, v5
  v_lshl_add_u32 v5, v4, 10, v5
  v_and_b32 v6, 1, v2
  v_lshl_add_u32 v5, v6, 3, v5
  v_lshrrev_b32 v6, 3, v3
  v_mul_u32_u24 v6, 3072, v6
  v_add_u32 v5, v5, v6
  v_add_u32 v41, 141312, v5
  s_mul_i32 s26, s24, 6
  s_add_u32 s26, s26, 2
  v_lshrrev_b32 v4, 1, v2
  v_add_u32 v4, s26, v4
  v_and_b32 v5, 7, v4
  v_lshrrev_b32 v4, 3, v4
  v_and_b32 v6, 7, v3
  v_xor_b32 v5, v5, v6
  v_lshlrev_b32 v5, 4, v5
  v_lshl_add_u32 v5, v6, 7, v5
  v_lshl_add_u32 v5, v4, 10, v5
  v_and_b32 v6, 1, v2
  v_lshl_add_u32 v5, v6, 3, v5
  v_lshrrev_b32 v6, 3, v3
  v_mul_u32_u24 v6, 3072, v6
  v_add_u32 v5, v5, v6
  v_add_u32 v42, 141312, v5
  s_mul_i32 s26, s24, 6
  s_add_u32 s26, s26, 4
  v_lshrrev_b32 v4, 1, v2
  v_add_u32 v4, s26, v4
  v_and_b32 v5, 7, v4
  v_lshrrev_b32 v4, 3, v4
  v_and_b32 v6, 7, v3
  v_xor_b32 v5, v5, v6
  v_lshlrev_b32 v5, 4, v5
  v_lshl_add_u32 v5, v6, 7, v5
  v_lshl_add_u32 v5, v4, 10, v5
  v_and_b32 v6, 1, v2
  v_lshl_add_u32 v5, v6, 3, v5
  v_lshrrev_b32 v6, 3, v3
  v_mul_u32_u24 v6, 3072, v6
  v_add_u32 v5, v5, v6
  v_add_u32 v43, 141312, v5
  v_lshrrev_b32 v4, 3, v1
  v_and_b32 v5, 7, v1
  s_mov_b32 s26, s24
  s_add_u32 s27, s26, s25
  s_lshr_b32 s28, s27, 1
  s_and_b32 s28, s28, 3
  s_lshl_b32 s28, s28, 1
  v_xor_b32 v6, s28, v5
  v_xor_b32 v6, v6, v4
  v_lshlrev_b32 v6, 4, v6
  v_lshl_add_u32 v6, v4, 7, v6
  s_mul_i32 s26, s26, 3072
  s_add_u32 s26, s26, 141312
  v_add_u32 v44, s26, v6
  s_lshr_b32 s28, s27, 5
  s_mul_i32 s28, s28, 12288
  s_and_b32 s27, s27, 31
  s_lshl_b32 s27, s27, 7
  s_add_u32 s28, s28, s27
  v_mul_u32_u24 v7, 503808, v4
  v_lshl_add_u32 v7, v5, 4, v7
  v_add_u32 v46, s28, v7
  s_and_b32 s26, s24, 1
  s_add_u32 s26, s26, 4
  s_add_u32 s27, s26, s25
  s_lshr_b32 s28, s27, 1
  s_and_b32 s28, s28, 3
  s_lshl_b32 s28, s28, 1
  v_xor_b32 v6, s28, v5
  v_xor_b32 v6, v6, v4
  v_lshlrev_b32 v6, 4, v6
  v_lshl_add_u32 v6, v4, 7, v6
  s_mul_i32 s26, s26, 3072
  s_add_u32 s26, s26, 141312
  v_add_u32 v45, s26, v6
  s_lshr_b32 s28, s27, 5
  s_mul_i32 s28, s28, 12288
  s_and_b32 s27, s27, 31
  s_lshl_b32 s27, s27, 7
  s_add_u32 s28, s28, s27
  v_mul_u32_u24 v7, 503808, v4
  v_lshl_add_u32 v7, v5, 4, v7
  v_add_u32 v47, s28, v7
  s_cmp_ge_u32 s24, 2
  s_cselect_b32 s28, 0x7f000000, 0
  v_or_b32 v47, s28, v47
  s_movk_i32 s34, 4096
  s_movk_i32 s35, 8192
  s_lshl_b32 s26, s24, 1
  s_add_u32 s26, s26, s25
  v_lshrrev_b32 v4, 3, v3
  v_add_u32 v4, s26, v4
  v_and_b32 v5, 7, v3
  v_mul_u32_u24 v5, 1296, v5
  v_add_u32 v4, v4, v5
  v_lshlrev_b32 v4, 3, v4
  v_add_u32 v4, 4194304, v4
  s_cmp_eq_u32 s24, 3
  s_cselect_b32 s27, 0, 1
  v_cmp_gt_u32 vcc, s27, v2
  v_mov_b32 v5, 0x7fffffff
  s_cmp_eq_u32 s24, 3
  s_cselect_b32 s26, 0, s24
  v_cndmask_b32 v48, v5, v4, vcc
  s_lshl_b32 s27, s26, 10
  v_add_u32 v37, s27, v37
  s_lshl_b32 s27, s26, 9
  s_add_u32 s27, s27, 161280
  v_lshlrev_b32 v4, 3, v1
  v_add_u32 v31, s27, v4
  v_add_u32 v32, 161280, v4
  s_waitcnt vmcnt(4)
  s_barrier
  ds_read_b64 v[50:51], v23 offset:0
  ds_read_b64 v[52:53], v23 offset:1024
  ds_read_b64 v[54:55], v23 offset:2048
  ds_read_b64 v[56:57], v24 offset:0
  ds_read_b64 v[58:59], v24 offset:1024
  ds_read_b64 v[60:61], v24 offset:2048
  ds_read_b64 v[62:63], v25 offset:0
  ds_read_b64 v[64:65], v25 offset:1024
  ds_read_b64 v[66:67], v25 offset:2048
  s_mov_b32 s26, 0x3f803f80
  v_mov_b32 v68, 0
  v_mov_b32 v74, 0
  v_mov_b32 v70, 0
  v_mov_b32 v76, 0
  v_mov_b32 v72, 0
  v_mov_b32 v78, 0
  s_waitcnt lgkmcnt(8)
  v_dot2c_f32_bf16 v68, s26, v50
  v_dot2c_f32_bf16 v74, v50, v50
  s_waitcnt lgkmcnt(5)
  v_dot2c_f32_bf16 v70, s26, v56
  v_dot2c_f32_bf16 v76, v56, v56
  s_waitcnt lgkmcnt(2)
  v_dot2c_f32_bf16 v72, s26, v62
  v_dot2c_f32_bf16 v78, v62, v62
  v_dot2c_f32_bf16 v68, s26, v51
  v_dot2c_f32_bf16 v74, v51, v51
  v_dot2c_f32_bf16 v70, s26, v57
  v_dot2c_f32_bf16 v76, v57, v57
  s_mov_b32 s39, 36864
  s_add_u32 m0, s29, 12288
  s_nop 0
  buffer_load_dwordx4 v9, s[12:15], s39 offen offset:0 lds
  v_dot2c_f32_bf16 v72, s26, v63
  v_dot2c_f32_bf16 v78, v63, v63
  v_dot2c_f32_bf16 v68, s26, v52
  v_dot2c_f32_bf16 v74, v52, v52
  v_dot2c_f32_bf16 v70, s26, v58
  v_dot2c_f32_bf16 v76, v58, v58
  s_waitcnt lgkmcnt(1)
  v_dot2c_f32_bf16 v72, s26, v64
  v_dot2c_f32_bf16 v78, v64, v64
  v_dot2c_f32_bf16 v68, s26, v53
  v_dot2c_f32_bf16 v74, v53, v53
  v_dot2c_f32_bf16 v70, s26, v59
  v_dot2c_f32_bf16 v76, v59, v59
  v_dot2c_f32_bf16 v72, s26, v65
  v_dot2c_f32_bf16 v78, v65, v65
  v_dot2c_f32_bf16 v68, s26, v54
  v_dot2c_f32_bf16 v74, v54, v54
  s_add_u32 m0, s29, 13184
  s_nop 0
  buffer_load_dwordx4 v9, s[12:15], s39 offen offset:128 lds
  v_dot2c_f32_bf16 v70, s26, v60
  v_dot2c_f32_bf16 v76, v60, v60
  s_waitcnt lgkmcnt(0)
  v_dot2c_f32_bf16 v72, s26, v66
  v_dot2c_f32_bf16 v78, v66, v66
  v_dot2c_f32_bf16 v68, s26, v55
  v_dot2c_f32_bf16 v74, v55, v55
  v_dot2c_f32_bf16 v70, s26, v61
  v_dot2c_f32_bf16 v76, v61, v61
  v_dot2c_f32_bf16 v72, s26, v67
  v_dot2c_f32_bf16 v78, v67, v67
  v_add_f32_dpp v68, v68, v68 row_ror:8 row_mask:0xf bank_mask:0xf
  v_add_f32_dpp v74, v74, v74 row_ror:8 row_mask:0xf bank_mask:0xf
  v_add_f32_dpp v70, v70, v70 row_ror:8 row_mask:0xf bank_mask:0xf
  v_add_f32_dpp v76, v76, v76 row_ror:8 row_mask:0xf bank_mask:0xf
  v_add_f32_dpp v72, v72, v72 row_ror:8 row_mask:0xf bank_mask:0xf
  v_add_f32_dpp v78, v78, v78 row_ror:8 row_mask:0xf bank_mask:0xf
  s_add_u32 m0, s29, 14080
  s_nop 0
  buffer_load_dwordx4 v9, s[12:15], s39 offen offset:256 lds
  v_add_f32_dpp v68, v68, v68 row_ror:4 row_mask:0xf bank_mask:0xf
  v_add_f32_dpp v74, v74, v74 row_ror:4 row_mask:0xf bank_mask:0xf
  v_add_f32_dpp v70, v70, v70 row_ror:4 row_mask:0xf bank_mask:0xf
  v_add_f32_dpp v76, v76, v76 row_ror:4 row_mask:0xf bank_mask:0xf
  v_add_f32_dpp v72, v72, v72 row_ror:4 row_mask:0xf bank_mask:0xf
  v_add_f32_dpp v78, v78, v78 row_ror:4 row_mask:0xf bank_mask:0xf
  v_add_f32_dpp v68, v68, v68 row_ror:2 row_mask:0xf bank_mask:0xf
  v_add_f32_dpp v74, v74, v74 row_ror:2 row_mask:0xf bank_mask:0xf
  v_add_f32_dpp v70, v70, v70 row_ror:2 row_mask:0xf bank_mask:0xf
  v_add_f32_dpp v76, v76, v76 row_ror:2 row_mask:0xf bank_mask:0xf
  v_add_f32_dpp v72, v72, v72 row_ror:2 row_mask:0xf bank_mask:0xf
  v_add_f32_dpp v78, v78, v78 row_ror:2 row_mask:0xf bank_mask:0xf
  v_add_f32_dpp v68, v68, v68 row_ror:1 row_mask:0xf bank_mask:0xf
  v_add_f32_dpp v74, v74, v74 row_ror:1 row_mask:0xf bank_mask:0xf
  v_add_f32_dpp v70, v70, v70 row_ror:1 row_mask:0xf bank_mask:0xf
  v_add_f32_dpp v76, v76, v76 row_ror:1 row_mask:0xf bank_mask:0xf
  s_mov_b32 s39, 73728
  s_add_u32 m0, s29, 24576
  s_nop 0
  buffer_load_dwordx4 v9, s[12:15], s39 offen offset:0 lds
  v_add_f32_dpp v72, v72, v72 row_ror:1 row_mask:0xf bank_mask:0xf
  v_add_f32_dpp v78, v78, v78 row_ror:1 row_mask:0xf bank_mask:0xf
  v_mul_f32 v68, s38, v68
  v_mul_f32 v70, s38, v70
  v_mul_f32 v72, s38, v72
  v_mul_f32 v4, v68, v68
  v_mul_f32 v5, v70, v70
  v_mul_f32 v6, v72, v72
  v_fma_f32 v74, v74, s38, -v4
  v_fma_f32 v76, v76, s38, -v5
  v_fma_f32 v78, v78, s38, -v6
  v_max_f32 v74, 0, v74
  v_max_f32 v76, 0, v76
  v_max_f32 v78, 0, v78
  v_add_f32 v74, 925353388, v74
  v_add_f32 v76, 925353388, v76
  s_add_u32 m0, s29, 25472
  s_nop 0
  buffer_load_dwordx4 v9, s[12:15], s39 offen offset:128 lds
  v_add_f32 v78, 925353388, v78
  v_rsq_f32 v74, v74
  v_rsq_f32 v76, v76
  v_rsq_f32 v78, v78
  v_mul_f32_e64 v68, -v68, v74
  v_mul_f32_e64 v70, -v70, v76
  v_mul_f32_e64 v72, -v72, v78
  v_lshlrev_b32 v80, 16, v50
  v_and_b32 v81, 0xffff0000, v50
  v_lshlrev_b32 v82, 16, v51
  v_and_b32 v83, 0xffff0000, v51
  v_lshlrev_b32 v84, 16, v52
  v_and_b32 v85, 0xffff0000, v52
  v_lshlrev_b32 v86, 16, v53
  v_and_b32 v87, 0xffff0000, v53
  v_lshlrev_b32 v88, 16, v54
  s_add_u32 m0, s29, 26368
  s_nop 0
  buffer_load_dwordx4 v9, s[12:15], s39 offen offset:256 lds
  v_and_b32 v89, 0xffff0000, v54
  v_lshlrev_b32 v90, 16, v55
  v_and_b32 v91, 0xffff0000, v55
  v_pk_fma_f32 v[80:81], v[80:81], v[74:75], v[68:69] op_sel_hi:[1,0,0]
  v_pk_fma_f32 v[82:83], v[82:83], v[74:75], v[68:69] op_sel_hi:[1,0,0]
  v_pk_fma_f32 v[84:85], v[84:85], v[74:75], v[68:69] op_sel_hi:[1,0,0]
  v_pk_fma_f32 v[86:87], v[86:87], v[74:75], v[68:69] op_sel_hi:[1,0,0]
  v_pk_fma_f32 v[88:89], v[88:89], v[74:75], v[68:69] op_sel_hi:[1,0,0]
  v_pk_fma_f32 v[90:91], v[90:91], v[74:75], v[68:69] op_sel_hi:[1,0,0]
  v_cvt_pk_bf16_f32 v50, v80, v81
  v_cvt_pk_bf16_f32 v51, v82, v83
  v_cvt_pk_bf16_f32 v52, v84, v85
  v_cvt_pk_bf16_f32 v53, v86, v87
  v_cvt_pk_bf16_f32 v54, v88, v89
  v_cvt_pk_bf16_f32 v55, v90, v91
  ds_write_b64 v26, v[50:51] offset:0
  s_mov_b32 s39, 110592
  s_add_u32 m0, s29, 36864
  s_nop 0
  buffer_load_dwordx4 v9, s[12:15], s39 offen offset:0 lds
  ds_write_b64 v26, v[52:53] offset:2048
  ds_write_b64 v26, v[54:55] offset:4096
  v_lshlrev_b32 v80, 16, v56
  v_and_b32 v81, 0xffff0000, v56
  v_lshlrev_b32 v82, 16, v57
  v_and_b32 v83, 0xffff0000, v57
  v_lshlrev_b32 v84, 16, v58
  v_and_b32 v85, 0xffff0000, v58
  v_lshlrev_b32 v86, 16, v59
  v_and_b32 v87, 0xffff0000, v59
  v_lshlrev_b32 v88, 16, v60
  v_and_b32 v89, 0xffff0000, v60
  v_lshlrev_b32 v90, 16, v61
  v_and_b32 v91, 0xffff0000, v61
  v_pk_fma_f32 v[80:81], v[80:81], v[76:77], v[70:71] op_sel_hi:[1,0,0]
  v_pk_fma_f32 v[82:83], v[82:83], v[76:77], v[70:71] op_sel_hi:[1,0,0]
  s_add_u32 m0, s29, 37760
  s_nop 0
  buffer_load_dwordx4 v9, s[12:15], s39 offen offset:128 lds
  v_pk_fma_f32 v[84:85], v[84:85], v[76:77], v[70:71] op_sel_hi:[1,0,0]
  v_pk_fma_f32 v[86:87], v[86:87], v[76:77], v[70:71] op_sel_hi:[1,0,0]
  v_pk_fma_f32 v[88:89], v[88:89], v[76:77], v[70:71] op_sel_hi:[1,0,0]
  v_pk_fma_f32 v[90:91], v[90:91], v[76:77], v[70:71] op_sel_hi:[1,0,0]
  v_cvt_pk_bf16_f32 v56, v80, v81
  v_cvt_pk_bf16_f32 v57, v82, v83
  v_cvt_pk_bf16_f32 v58, v84, v85
  v_cvt_pk_bf16_f32 v59, v86, v87
  v_cvt_pk_bf16_f32 v60, v88, v89
  v_cvt_pk_bf16_f32 v61, v90, v91
  ds_write_b64 v27, v[56:57] offset:0
  ds_write_b64 v27, v[58:59] offset:2048
  ds_write_b64 v27, v[60:61] offset:4096
  v_lshlrev_b32 v80, 16, v62
  v_and_b32 v81, 0xffff0000, v62
  v_lshlrev_b32 v82, 16, v63
  s_add_u32 m0, s29, 38656
  s_nop 0
  buffer_load_dwordx4 v9, s[12:15], s39 offen offset:256 lds
  v_and_b32 v83, 0xffff0000, v63
  v_lshlrev_b32 v84, 16, v64
  v_and_b32 v85, 0xffff0000, v64
  v_lshlrev_b32 v86, 16, v65
  v_and_b32 v87, 0xffff0000, v65
  v_lshlrev_b32 v88, 16, v66
  v_and_b32 v89, 0xffff0000, v66
  v_lshlrev_b32 v90, 16, v67
  v_and_b32 v91, 0xffff0000, v67
  v_pk_fma_f32 v[80:81], v[80:81], v[78:79], v[72:73] op_sel_hi:[1,0,0]
  v_pk_fma_f32 v[82:83], v[82:83], v[78:79], v[72:73] op_sel_hi:[1,0,0]
  v_pk_fma_f32 v[84:85], v[84:85], v[78:79], v[72:73] op_sel_hi:[1,0,0]
  v_pk_fma_f32 v[86:87], v[86:87], v[78:79], v[72:73] op_sel_hi:[1,0,0]
  v_pk_fma_f32 v[88:89], v[88:89], v[78:79], v[72:73] op_sel_hi:[1,0,0]
  v_pk_fma_f32 v[90:91], v[90:91], v[78:79], v[72:73] op_sel_hi:[1,0,0]
  v_cvt_pk_bf16_f32 v62, v80, v81
  v_cvt_pk_bf16_f32 v63, v82, v83
  v_cvt_pk_bf16_f32 v64, v84, v85
  v_cvt_pk_bf16_f32 v65, v86, v87
  v_cvt_pk_bf16_f32 v66, v88, v89
  v_cvt_pk_bf16_f32 v67, v90, v91
  ds_write_b64 v28, v[62:63] offset:0
  ds_write_b64 v28, v[64:65] offset:2048
  ds_write_b64 v28, v[66:67] offset:4096
  s_waitcnt vmcnt(6) lgkmcnt(0)
  s_barrier
  ds_read_b128 a[0:3], v20 offset:0
  ds_read_b128 a[24:27], v20 offset:6144
  ds_read_b128 a[48:51], v20 offset:12288
  ds_read_b64_tr_b16 a[72:73], v11 offset:0
  ds_read_b64_tr_b16 a[74:75], v11 offset:6144
  ds_read_b64_tr_b16 a[76:77], v12 offset:0
  ds_read_b64_tr_b16 a[78:79], v12 offset:6144
  ds_read_b64_tr_b16 a[80:81], v13 offset:0
  ds_read_b64_tr_b16 a[82:83], v13 offset:6144
  ds_read_b128 a[4:7], v21 offset:1024
  ds_read_b128 a[28:31], v21 offset:7168
  ds_read_b128 a[52:55], v21 offset:13312
  ds_read_b64_tr_b16 a[84:85], v11 offset:12288
  s_waitcnt lgkmcnt(8)
  v_mfma_f32_16x16x32_bf16 v[68:71], a[72:75], a[0:3], 0
  ds_read_b64_tr_b16 a[86:87], v11 offset:18432
  s_mov_b32 s39, 147456
  s_add_u32 m0, s29, 49152
  v_mfma_f32_16x16x32_bf16 v[72:75], a[72:75], a[24:27], 0
  buffer_load_dwordx4 v9, s[12:15], s39 offen offset:0 lds
  s_add_u32 m0, s29, 50048
  v_mfma_f32_16x16x32_bf16 v[76:79], a[72:75], a[48:51], 0
  buffer_load_dwordx4 v9, s[12:15], s39 offen offset:128 lds
  ds_read_b128 a[8:11], v20 offset:2048
  ds_read_b128 a[32:35], v20 offset:8192
  ds_read_b128 a[56:59], v20 offset:14336
  ds_read_b64_tr_b16 a[88:89], v12 offset:12288
  s_waitcnt lgkmcnt(11)
  v_mfma_f32_16x16x32_bf16 v[80:83], a[76:79], a[0:3], 0
  ds_read_b64_tr_b16 a[90:91], v12 offset:18432
  s_add_u32 m0, s29, 50944
  v_mfma_f32_16x16x32_bf16 v[84:87], a[76:79], a[24:27], 0
  buffer_load_dwordx4 v9, s[12:15], s39 offen offset:256 lds
  s_mov_b32 s39, 184320
  s_add_u32 m0, s29, 61440
  v_mfma_f32_16x16x32_bf16 v[88:91], a[76:79], a[48:51], 0
  buffer_load_dwordx4 v9, s[12:15], s39 offen offset:0 lds
  ds_read_b128 a[12:15], v21 offset:3072
  ds_read_b128 a[36:39], v21 offset:9216
  ds_read_b128 a[60:63], v21 offset:15360
  ds_read_b64_tr_b16 a[72:73], v13 offset:12288
  s_waitcnt lgkmcnt(14)
  v_mfma_f32_16x16x32_bf16 v[92:95], a[80:83], a[0:3], 0
  ds_read_b64_tr_b16 a[74:75], v13 offset:18432
  s_add_u32 m0, s29, 62336
  v_mfma_f32_16x16x32_bf16 v[96:99], a[80:83], a[24:27], 0
  buffer_load_dwordx4 v9, s[12:15], s39 offen offset:128 lds
  s_add_u32 m0, s29, 63232
  v_mfma_f32_16x16x32_bf16 v[100:103], a[80:83], a[48:51], 0
  buffer_load_dwordx4 v9, s[12:15], s39 offen offset:256 lds
  ds_read_b128 a[16:19], v20 offset:4096
  ds_read_b128 a[40:43], v20 offset:10240
  ds_read_b128 a[64:67], v20 offset:16384
  s_waitcnt vmcnt(6)
  s_barrier
  ds_read_b64_tr_b16 a[76:77], v11 offset:24576
  s_waitcnt lgkmcnt(14)
  v_mfma_f32_16x16x32_bf16 v[68:71], a[84:87], a[4:7], v[68:71]
  ds_read_b64_tr_b16 a[78:79], v11 offset:30720
  s_mov_b32 s39, 384
  s_add_u32 m0, s29, 73728
  v_mfma_f32_16x16x32_bf16 v[72:75], a[84:87], a[28:31], v[72:75]
  buffer_load_dwordx4 v9, s[12:15], s39 offen offset:0 lds
  v_mfma_f32_16x16x32_bf16 v[76:79], a[84:87], a[52:55], v[76:79]
  ds_read_b128 a[20:23], v21 offset:5120
  ds_read_b128 a[44:47], v21 offset:11264
  ds_read_b128 a[68:71], v21 offset:17408
  ds_read_b64_tr_b16 a[80:81], v12 offset:24576
  s_waitcnt lgkmcnt(14)
  v_mfma_f32_16x16x32_bf16 v[80:83], a[88:91], a[4:7], v[80:83]
  ds_read_b64_tr_b16 a[82:83], v12 offset:30720
  s_add_u32 m0, s29, 74624
  v_mfma_f32_16x16x32_bf16 v[84:87], a[88:91], a[28:31], v[84:87]
  buffer_load_dwordx4 v9, s[12:15], s39 offen offset:128 lds
  v_mfma_f32_16x16x32_bf16 v[88:91], a[88:91], a[52:55], v[88:91]
  ds_read_b64_tr_b16 a[84:85], v13 offset:24576
  s_waitcnt lgkmcnt(11)
  v_mfma_f32_16x16x32_bf16 v[92:95], a[72:75], a[4:7], v[92:95]
  ds_read_b64_tr_b16 a[86:87], v13 offset:30720
  s_add_u32 m0, s29, 75520
  v_mfma_f32_16x16x32_bf16 v[96:99], a[72:75], a[28:31], v[96:99]
  buffer_load_dwordx4 v9, s[12:15], s39 offen offset:256 lds
  v_mfma_f32_16x16x32_bf16 v[100:103], a[72:75], a[52:55], v[100:103]
  ds_read_b64_tr_b16 a[88:89], v11 offset:36864
  s_waitcnt lgkmcnt(8)
  v_mfma_f32_16x16x32_bf16 v[68:71], a[76:79], a[8:11], v[68:71]
  ds_read_b64_tr_b16 a[90:91], v11 offset:43008
  s_mov_b32 s39, 37248
  s_add_u32 m0, s29, 86016
  v_mfma_f32_16x16x32_bf16 v[72:75], a[76:79], a[32:35], v[72:75]
  buffer_load_dwordx4 v9, s[12:15], s39 offen offset:0 lds
  s_add_u32 m0, s29, 86912
  v_mfma_f32_16x16x32_bf16 v[76:79], a[76:79], a[56:59], v[76:79]
  buffer_load_dwordx4 v9, s[12:15], s39 offen offset:128 lds
  ds_read_b64_tr_b16 a[72:73], v12 offset:36864
  s_waitcnt lgkmcnt(5)
  v_mfma_f32_16x16x32_bf16 v[80:83], a[80:83], a[8:11], v[80:83]
  ds_read_b64_tr_b16 a[74:75], v12 offset:43008
  s_add_u32 m0, s29, 87808
  v_mfma_f32_16x16x32_bf16 v[84:87], a[80:83], a[32:35], v[84:87]
  buffer_load_dwordx4 v9, s[12:15], s39 offen offset:256 lds
  v_mfma_f32_16x16x32_bf16 v[88:91], a[80:83], a[56:59], v[88:91]
  ds_read_b64_tr_b16 a[76:77], v13 offset:36864
  s_waitcnt lgkmcnt(5)
  v_mfma_f32_16x16x32_bf16 v[92:95], a[84:87], a[8:11], v[92:95]
  ds_read_b64_tr_b16 a[78:79], v13 offset:43008
  s_mov_b32 s39, 74112
  s_add_u32 m0, s29, 98304
  v_mfma_f32_16x16x32_bf16 v[96:99], a[84:87], a[32:35], v[96:99]
  buffer_load_dwordx4 v9, s[12:15], s39 offen offset:0 lds
  v_mfma_f32_16x16x32_bf16 v[100:103], a[84:87], a[56:59], v[100:103]
  s_waitcnt vmcnt(7)
  s_barrier
  ds_read_b64_tr_b16 a[80:81], v14 offset:0
  s_waitcnt lgkmcnt(5)
  v_mfma_f32_16x16x32_bf16 v[68:71], a[88:91], a[12:15], v[68:71]
  ds_read_b64_tr_b16 a[82:83], v14 offset:6144
  s_add_u32 m0, s29, 99200
  v_mfma_f32_16x16x32_bf16 v[72:75], a[88:91], a[36:39], v[72:75]
  buffer_load_dwordx4 v9, s[12:15], s39 offen offset:128 lds
  v_mfma_f32_16x16x32_bf16 v[76:79], a[88:91], a[60:63], v[76:79]
  ds_read_b64_tr_b16 a[84:85], v15 offset:0
  s_waitcnt lgkmcnt(5)
  v_mfma_f32_16x16x32_bf16 v[80:83], a[72:75], a[12:15], v[80:83]
  ds_read_b64_tr_b16 a[86:87], v15 offset:6144
  s_add_u32 m0, s29, 100096
  v_mfma_f32_16x16x32_bf16 v[84:87], a[72:75], a[36:39], v[84:87]
  buffer_load_dwordx4 v9, s[12:15], s39 offen offset:256 lds
  v_mfma_f32_16x16x32_bf16 v[88:91], a[72:75], a[60:63], v[88:91]
  ds_read_b64_tr_b16 a[88:89], v16 offset:0
  s_waitcnt lgkmcnt(5)
  v_mfma_f32_16x16x32_bf16 v[92:95], a[76:79], a[12:15], v[92:95]
  ds_read_b64_tr_b16 a[90:91], v16 offset:6144
  s_mov_b32 s39, 110976
  s_add_u32 m0, s29, 110592
  v_mfma_f32_16x16x32_bf16 v[96:99], a[76:79], a[36:39], v[96:99]
  buffer_load_dwordx4 v9, s[12:15], s39 offen offset:0 lds
  v_mfma_f32_16x16x32_bf16 v[100:103], a[76:79], a[60:63], v[100:103]
  ds_read_b64_tr_b16 a[72:73], v14 offset:12288
  s_waitcnt lgkmcnt(5)
  v_mfma_f32_16x16x32_bf16 v[68:71], a[80:83], a[16:19], v[68:71]
  ds_read_b64_tr_b16 a[74:75], v14 offset:18432
  s_add_u32 m0, s29, 111488
  v_mfma_f32_16x16x32_bf16 v[72:75], a[80:83], a[40:43], v[72:75]
  buffer_load_dwordx4 v9, s[12:15], s39 offen offset:128 lds
  s_add_u32 m0, s29, 112384
  v_mfma_f32_16x16x32_bf16 v[76:79], a[80:83], a[64:67], v[76:79]
  buffer_load_dwordx4 v9, s[12:15], s39 offen offset:256 lds
  ds_read_b64_tr_b16 a[76:77], v15 offset:12288
  s_waitcnt lgkmcnt(5)
  v_mfma_f32_16x16x32_bf16 v[80:83], a[84:87], a[16:19], v[80:83]
  ds_read_b64_tr_b16 a[78:79], v15 offset:18432
  s_mov_b32 s39, 147840
  s_add_u32 m0, s29, 0
  v_mfma_f32_16x16x32_bf16 v[84:87], a[84:87], a[40:43], v[84:87]
  buffer_load_dwordx4 v9, s[12:15], s39 offen offset:0 lds
  v_mfma_f32_16x16x32_bf16 v[88:91], a[84:87], a[64:67], v[88:91]
  ds_read_b64_tr_b16 a[80:81], v16 offset:12288
  s_waitcnt lgkmcnt(5)
  v_mfma_f32_16x16x32_bf16 v[92:95], a[88:91], a[16:19], v[92:95]
  ds_read_b64_tr_b16 a[82:83], v16 offset:18432
  s_add_u32 m0, s29, 896
  v_mfma_f32_16x16x32_bf16 v[96:99], a[88:91], a[40:43], v[96:99]
  buffer_load_dwordx4 v9, s[12:15], s39 offen offset:128 lds
  v_mfma_f32_16x16x32_bf16 v[100:103], a[88:91], a[64:67], v[100:103]
  s_waitcnt vmcnt(8)
  s_barrier
  ds_read_b64_tr_b16 a[84:85], v14 offset:24576
  s_waitcnt lgkmcnt(5)
  v_mfma_f32_16x16x32_bf16 v[68:71], a[72:75], a[20:23], v[68:71]
  ds_read_b64_tr_b16 a[86:87], v14 offset:30720
  s_add_u32 m0, s29, 1792
  v_mfma_f32_16x16x32_bf16 v[72:75], a[72:75], a[44:47], v[72:75]
  buffer_load_dwordx4 v9, s[12:15], s39 offen offset:256 lds
  v_mfma_f32_16x16x32_bf16 v[76:79], a[72:75], a[68:71], v[76:79]
  ds_read_b64_tr_b16 a[88:89], v15 offset:24576
  s_waitcnt lgkmcnt(5)
  v_mfma_f32_16x16x32_bf16 v[80:83], a[76:79], a[20:23], v[80:83]
  ds_read_b64_tr_b16 a[90:91], v15 offset:30720
  s_mov_b32 s39, 184704
  s_add_u32 m0, s29, 12288
  v_mfma_f32_16x16x32_bf16 v[84:87], a[76:79], a[44:47], v[84:87]
  buffer_load_dwordx4 v9, s[12:15], s39 offen offset:0 lds
  v_mfma_f32_16x16x32_bf16 v[88:91], a[76:79], a[68:71], v[88:91]
  ds_read_b64_tr_b16 a[72:73], v16 offset:24576
  s_waitcnt lgkmcnt(5)
  v_mfma_f32_16x16x32_bf16 v[92:95], a[80:83], a[20:23], v[92:95]
  ds_read_b64_tr_b16 a[74:75], v16 offset:30720
  s_add_u32 m0, s29, 13184
  v_mfma_f32_16x16x32_bf16 v[96:99], a[80:83], a[44:47], v[96:99]
  buffer_load_dwordx4 v9, s[12:15], s39 offen offset:128 lds
  v_mfma_f32_16x16x32_bf16 v[100:103], a[80:83], a[68:71], v[100:103]
  ds_read_b64_tr_b16 a[76:77], v14 offset:36864
  s_waitcnt lgkmcnt(5)
  v_mfma_f32_16x16x32_bf16 v[104:107], a[84:87], a[0:3], 0
  ds_read_b64_tr_b16 a[78:79], v14 offset:43008
  s_add_u32 m0, s29, 14080
  v_mfma_f32_16x16x32_bf16 v[108:111], a[84:87], a[24:27], 0
  buffer_load_dwordx4 v9, s[12:15], s39 offen offset:256 lds
  v_mfma_f32_16x16x32_bf16 v[112:115], a[84:87], a[48:51], 0
  ds_read_b64 v[176:177], v41 offset:0
  ds_read_b64 v[178:179], v42 offset:0
  ds_read_b64 v[180:181], v43 offset:0
  ds_read_b64 v[182:183], v41 offset:6144
  ds_read_b64 v[184:185], v42 offset:6144
  ds_read_b64_tr_b16 a[80:81], v15 offset:36864
  s_waitcnt lgkmcnt(10)
  v_mfma_f32_16x16x32_bf16 v[116:119], a[88:91], a[0:3], 0
  ds_read_b64_tr_b16 a[82:83], v15 offset:43008
  ds_read_b64 v[186:187], v43 offset:6144
  v_mfma_f32_16x16x32_bf16 v[120:123], a[88:91], a[24:27], 0
  ds_read_b64 v[188:189], v41 offset:12288
  ds_read_b64 v[190:191], v42 offset:12288
  v_mfma_f32_16x16x32_bf16 v[124:127], a[88:91], a[48:51], 0
  ds_read_b64 v[192:193], v43 offset:12288
  ds_read_b64_tr_b16 a[84:85], v16 offset:36864
  s_waitcnt lgkmcnt(14)
  v_mfma_f32_16x16x32_bf16 v[128:131], a[72:75], a[0:3], 0
  ds_read_b64_tr_b16 a[86:87], v16 offset:43008
  v_cvt_pk_bf16_f32 v140, v68, v69
  v_mfma_f32_16x16x32_bf16 v[132:135], a[72:75], a[24:27], 0
  v_cvt_pk_bf16_f32 v141, v70, v71
  v_cvt_pk_bf16_f32 v142, v80, v81
  v_mfma_f32_16x16x32_bf16 v[136:139], a[72:75], a[48:51], 0
  v_cvt_pk_bf16_f32 v143, v82, v83
  s_waitcnt vmcnt(6)
  s_barrier
  ds_read_b64_tr_b16 a[88:89], v17 offset:0
  s_waitcnt lgkmcnt(14)
  v_mfma_f32_16x16x32_bf16 v[104:107], a[76:79], a[4:7], v[104:107]
  ds_read_b64_tr_b16 a[90:91], v17 offset:6144
  v_cvt_pk_bf16_f32 v144, v92, v93
  v_mfma_f32_16x16x32_bf16 v[108:111], a[76:79], a[28:31], v[108:111]
  v_cvt_pk_bf16_f32 v145, v94, v95
  v_cvt_pk_bf16_f32 v146, v72, v73
  v_mfma_f32_16x16x32_bf16 v[112:115], a[76:79], a[52:55], v[112:115]
  v_cvt_pk_bf16_f32 v147, v74, v75
  v_cvt_pk_bf16_f32 v148, v84, v85
  ds_read_b64_tr_b16 a[72:73], v18 offset:0
  s_waitcnt lgkmcnt(9)
  v_mfma_f32_16x16x32_bf16 v[116:119], a[80:83], a[4:7], v[116:119]
  ds_read_b64_tr_b16 a[74:75], v18 offset:6144
  v_cvt_pk_bf16_f32 v149, v86, v87
  v_mfma_f32_16x16x32_bf16 v[120:123], a[80:83], a[28:31], v[120:123]
  v_cvt_pk_bf16_f32 v150, v96, v97
  v_cvt_pk_bf16_f32 v151, v98, v99
  v_mfma_f32_16x16x32_bf16 v[124:127], a[80:83], a[52:55], v[124:127]
  v_cvt_pk_bf16_f32 v152, v76, v77
  v_cvt_pk_bf16_f32 v153, v78, v79
  ds_read_b64_tr_b16 a[76:77], v19 offset:0
  s_waitcnt lgkmcnt(5)
  v_mfma_f32_16x16x32_bf16 v[128:131], a[84:87], a[4:7], v[128:131]
  ds_read_b64_tr_b16 a[78:79], v19 offset:6144
  v_cvt_pk_bf16_f32 v154, v88, v89
  v_mfma_f32_16x16x32_bf16 v[132:135], a[84:87], a[28:31], v[132:135]
  v_cvt_pk_bf16_f32 v155, v90, v91
  v_cvt_pk_bf16_f32 v156, v100, v101
  v_mfma_f32_16x16x32_bf16 v[136:139], a[84:87], a[52:55], v[136:139]
  v_cvt_pk_bf16_f32 v157, v102, v103
  ds_read_b64_tr_b16 a[80:81], v17 offset:12288
  s_waitcnt lgkmcnt(5)
  v_mfma_f32_16x16x32_bf16 v[104:107], a[88:91], a[8:11], v[104:107]
  ds_read_b64_tr_b16 a[82:83], v17 offset:18432
  v_lshlrev_b32 v220, 16, v176
  v_mfma_f32_16x16x32_bf16 v[108:111], a[88:91], a[32:35], v[108:111]
  v_and_b32 v221, 0xffff0000, v176
  v_lshlrev_b32 v222, 16, v177
  v_mfma_f32_16x16x32_bf16 v[112:115], a[88:91], a[56:59], v[112:115]
  ds_read_b64_tr_b16 a[84:85], v18 offset:12288
  s_waitcnt lgkmcnt(5)
  v_mfma_f32_16x16x32_bf16 v[116:119], a[72:75], a[8:11], v[116:119]
  ds_read_b64_tr_b16 a[86:87], v18 offset:18432
  v_and_b32 v223, 0xffff0000, v177
  v_mfma_f32_16x16x32_bf16 v[120:123], a[72:75], a[32:35], v[120:123]
  v_lshlrev_b32 v232, 16, v178
  v_and_b32 v233, 0xffff0000, v178
  v_mfma_f32_16x16x32_bf16 v[124:127], a[72:75], a[56:59], v[124:127]
  ds_read_b64_tr_b16 a[88:89], v19 offset:12288
  s_waitcnt lgkmcnt(5)
  v_mfma_f32_16x16x32_bf16 v[128:131], a[76:79], a[8:11], v[128:131]
  ds_read_b64_tr_b16 a[90:91], v19 offset:18432
  v_lshlrev_b32 v234, 16, v179
  v_mfma_f32_16x16x32_bf16 v[132:135], a[76:79], a[32:35], v[132:135]
  v_and_b32 v235, 0xffff0000, v179
  v_lshlrev_b32 v244, 16, v180
  v_mfma_f32_16x16x32_bf16 v[136:139], a[76:79], a[56:59], v[136:139]
  s_waitcnt vmcnt(0)
  s_barrier
  ds_read_b64_tr_b16 a[72:73], v11 offset:0
  s_waitcnt lgkmcnt(5)
  v_mfma_f32_16x16x32_bf16 v[104:107], a[80:83], a[12:15], v[104:107]
  ds_read_b64_tr_b16 a[74:75], v11 offset:6144
  v_and_b32 v245, 0xffff0000, v180
  v_mfma_f32_16x16x32_bf16 v[108:111], a[80:83], a[36:39], v[108:111]
  v_lshlrev_b32 v246, 16, v181
  v_and_b32 v247, 0xffff0000, v181
  v_mfma_f32_16x16x32_bf16 v[112:115], a[80:83], a[60:63], v[112:115]
  ds_read_b64_tr_b16 a[76:77], v12 offset:0
  s_waitcnt lgkmcnt(5)
  v_mfma_f32_16x16x32_bf16 v[116:119], a[84:87], a[12:15], v[116:119]
  ds_read_b64_tr_b16 a[78:79], v12 offset:6144
  v_lshlrev_b32 v224, 16, v182
  v_mfma_f32_16x16x32_bf16 v[120:123], a[84:87], a[36:39], v[120:123]
  v_and_b32 v225, 0xffff0000, v182
  v_lshlrev_b32 v226, 16, v183
  v_mfma_f32_16x16x32_bf16 v[124:127], a[84:87], a[60:63], v[124:127]
  ds_read_b64_tr_b16 a[80:81], v13 offset:0
  s_waitcnt lgkmcnt(5)
  v_mfma_f32_16x16x32_bf16 v[128:131], a[88:91], a[12:15], v[128:131]
  ds_read_b64_tr_b16 a[82:83], v13 offset:6144
  v_and_b32 v227, 0xffff0000, v183
  v_mfma_f32_16x16x32_bf16 v[132:135], a[88:91], a[36:39], v[132:135]
  v_lshlrev_b32 v236, 16, v184
  v_and_b32 v237, 0xffff0000, v184
  v_mfma_f32_16x16x32_bf16 v[136:139], a[88:91], a[60:63], v[136:139]
  buffer_load_dword v206, off, s[52:55], 0 offset:128 sc1
  ds_read_b64_tr_b16 a[84:85], v11 offset:12288
  s_waitcnt lgkmcnt(5)
  v_mfma_f32_16x16x32_bf16 v[104:107], a[72:75], a[16:19], v[104:107]
  ds_read_b64_tr_b16 a[86:87], v11 offset:18432
  v_lshlrev_b32 v238, 16, v185
  v_mfma_f32_16x16x32_bf16 v[108:111], a[72:75], a[40:43], v[108:111]
  v_and_b32 v239, 0xffff0000, v185
  v_lshlrev_b32 v248, 16, v186
  v_mfma_f32_16x16x32_bf16 v[112:115], a[72:75], a[64:67], v[112:115]
  ds_read_b64_tr_b16 a[88:89], v12 offset:12288
  s_waitcnt lgkmcnt(5)
  v_mfma_f32_16x16x32_bf16 v[116:119], a[76:79], a[16:19], v[116:119]
  ds_read_b64_tr_b16 a[90:91], v12 offset:18432
  v_and_b32 v249, 0xffff0000, v186
  v_mfma_f32_16x16x32_bf16 v[120:123], a[76:79], a[40:43], v[120:123]
  v_lshlrev_b32 v250, 16, v187
  v_and_b32 v251, 0xffff0000, v187
  v_mfma_f32_16x16x32_bf16 v[124:127], a[76:79], a[64:67], v[124:127]
  ds_read_b64_tr_b16 a[72:73], v13 offset:12288
  s_waitcnt lgkmcnt(5)
  v_mfma_f32_16x16x32_bf16 v[128:131], a[80:83], a[16:19], v[128:131]
  ds_read_b64_tr_b16 a[74:75], v13 offset:18432
  v_lshlrev_b32 v228, 16, v188
  v_mfma_f32_16x16x32_bf16 v[132:135], a[80:83], a[40:43], v[132:135]
  v_and_b32 v229, 0xffff0000, v188
  v_lshlrev_b32 v230, 16, v189
  v_mfma_f32_16x16x32_bf16 v[136:139], a[80:83], a[64:67], v[136:139]
  s_waitcnt lgkmcnt(4)
  v_mfma_f32_16x16x32_bf16 v[104:107], a[84:87], a[20:23], v[104:107]
  v_and_b32 v231, 0xffff0000, v189
  v_mfma_f32_16x16x32_bf16 v[108:111], a[84:87], a[44:47], v[108:111]
  v_lshlrev_b32 v240, 16, v190
  v_and_b32 v241, 0xffff0000, v190
  v_mfma_f32_16x16x32_bf16 v[112:115], a[84:87], a[68:71], v[112:115]
  s_waitcnt lgkmcnt(2)
  v_mfma_f32_16x16x32_bf16 v[116:119], a[88:91], a[20:23], v[116:119]
  v_lshlrev_b32 v242, 16, v191
  v_mfma_f32_16x16x32_bf16 v[120:123], a[88:91], a[44:47], v[120:123]
  v_and_b32 v243, 0xffff0000, v191
  v_lshlrev_b32 v252, 16, v192
  v_mfma_f32_16x16x32_bf16 v[124:127], a[88:91], a[68:71], v[124:127]
  s_waitcnt lgkmcnt(0)
  v_mfma_f32_16x16x32_bf16 v[128:131], a[72:75], a[20:23], v[128:131]
  v_and_b32 v253, 0xffff0000, v192
  v_mfma_f32_16x16x32_bf16 v[132:135], a[72:75], a[44:47], v[132:135]
  v_lshlrev_b32 v254, 16, v193
  v_and_b32 v255, 0xffff0000, v193
  v_mfma_f32_16x16x32_bf16 v[136:139], a[72:75], a[68:71], v[136:139]
  v_cvt_pk_bf16_f32 v158, v104, v105
  v_cvt_pk_bf16_f32 v159, v106, v107
  v_cvt_pk_bf16_f32 v160, v116, v117
  v_cvt_pk_bf16_f32 v161, v118, v119
  v_cvt_pk_bf16_f32 v162, v128, v129
  v_cvt_pk_bf16_f32 v163, v130, v131
  v_cvt_pk_bf16_f32 v164, v108, v109
  v_cvt_pk_bf16_f32 v165, v110, v111
  v_cvt_pk_bf16_f32 v166, v120, v121
  v_cvt_pk_bf16_f32 v167, v122, v123
  v_cvt_pk_bf16_f32 v168, v132, v133
  v_cvt_pk_bf16_f32 v169, v134, v135
  v_cvt_pk_bf16_f32 v170, v112, v113
  v_cvt_pk_bf16_f32 v171, v114, v115
  v_cvt_pk_bf16_f32 v172, v124, v125
  v_cvt_pk_bf16_f32 v173, v126, v127
  v_cvt_pk_bf16_f32 v174, v136, v137
  v_cvt_pk_bf16_f32 v175, v138, v139
  v_mfma_f32_16x16x32_bf16 v[194:197], v[158:161], v[140:143], 0
  v_mfma_f32_16x16x32_bf16 v[198:201], v[164:167], v[146:149], 0
  v_mfma_f32_16x16x32_bf16 v[202:205], v[170:173], v[152:155], 0
  s_waitcnt vmcnt(0)
  v_readfirstlane_b32 s26, v206
  s_mul_i32 s27, s24, 18432
  s_add_u32 s40, s27, 9175040
  s_add_u32 s41, s40, 12288
  v_lshlrev_b32 v207, 4, v1
  v_mfma_f32_16x16x16_bf16 v[194:197], v[162:163], v[144:145], v[194:197]
  v_mfma_f32_16x16x16_bf16 v[198:201], v[168:169], v[150:151], v[198:201]
  v_mfma_f32_16x16x16_bf16 v[202:205], v[174:175], v[156:157], v[202:205]
  v_add_u32 v208, 4096, v207
  v_add_u32 v209, 8192, v207
  s_nop 3
  ds_write_b128 v36, v[194:197] offset:0
  ds_write_b128 v36, v[198:201] offset:1024
  ds_write_b128 v36, v[202:205] offset:2048
  s_cmp_eq_u32 s24, 0
  s_cselect_b32 s26, s26, 1
  s_cmp_eq_u32 s26, 0
  s_cbranch_scc1 LA_wspin
LA_wok:
  s_waitcnt lgkmcnt(0)
  s_barrier
  s_lshr_b32 s26, s43, 3
  s_mul_i32 s26, s26, 22
  v_add_u32 v4, s26, v1
  v_cmp_gt_u32 vcc, 22, v1
  v_lshlrev_b32 v4, 7, v4
  v_mov_b32 v5, 0x7ffffff0
  s_mov_b32 s26, 9175040
  v_cndmask_b32 v4, v5, v4, vcc
  buffer_load_dword v30, v4, s[20:23], s26 offen sc1
  ds_read_b128 v[140:143], v37 offset:0
  ds_read_b128 v[144:147], v37 offset:3072
  ds_read_b128 v[148:151], v37 offset:6144
  ds_read_b128 v[152:155], v37 offset:9216
  buffer_load_dwordx4 a[96:99], v207, s[20:23], s40 offen offset:0 sc1
  buffer_load_dwordx4 a[120:123], v208, s[20:23], s40 offen offset:2048 sc1
  buffer_load_dwordx4 a[144:147], v207, s[20:23], s41 offen offset:0 sc1
  s_waitcnt lgkmcnt(2)
  v_pk_add_f32 v[140:141], v[140:141], v[144:145]
  v_pk_add_f32 v[142:143], v[142:143], v[146:147]
  s_waitcnt lgkmcnt(0)
  v_pk_add_f32 v[148:149], v[148:149], v[152:153]
  v_pk_add_f32 v[150:151], v[150:151], v[154:155]
  buffer_load_dwordx4 a[100:103], v207, s[20:23], s40 offen offset:1024 sc1
  v_pk_add_f32 v[140:141], v[140:141], v[148:149]
  v_pk_add_f32 v[142:143], v[142:143], v[150:151]
  v_max3_f32 v144, v140, v141, v142
  v_max_f32 v144, v144, v143
  buffer_load_dwordx4 a[124:127], v208, s[20:23], s40 offen offset:3072 sc1
  v_mov_b32 v145, v144
  s_nop 1
  v_permlane16_swap_b32 v144, v145
  v_max_f32 v144, v144, v145
  buffer_load_dwordx4 a[148:151], v207, s[20:23], s41 offen offset:1024 sc1
  v_mul_f32 v144, s30, v144
  v_fma_f32 v140, v140, s30, -v144
  v_fma_f32 v141, v141, s30, -v144
  v_fma_f32 v142, v142, s30, -v144
  buffer_load_dwordx4 a[104:107], v207, s[20:23], s40 offen offset:2048 sc1
  v_fma_f32 v143, v143, s30, -v144
  v_exp_f32 v140, v140
  v_exp_f32 v141, v141
  v_exp_f32 v142, v142
  buffer_load_dwordx4 a[128:131], v209, s[20:23], s40 offen offset:0 sc1
  v_exp_f32 v143, v143
  v_add_f32 v144, v140, v141
  v_add_f32 v145, v142, v143
  v_add_f32 v144, v144, v145
  buffer_load_dwordx4 a[152:155], v207, s[20:23], s41 offen offset:2048 sc1
  v_mov_b32 v145, v144
  s_nop 1
  v_permlane16_swap_b32 v144, v145
  v_add_f32 v144, v144, v145
  buffer_load_dwordx4 a[108:111], v207, s[20:23], s40 offen offset:3072 sc1
  v_rcp_f32 v144, v144
  s_nop 0
  v_cndmask_b32 v144, 0, v144, s[32:33]
  v_pk_mul_f32 v[140:141], v[140:141], v[144:145] op_sel_hi:[1,0]
  buffer_load_dwordx4 a[132:135], v209, s[20:23], s40 offen offset:1024 sc1
  v_pk_mul_f32 v[142:143], v[142:143], v[144:145] op_sel_hi:[1,0]
  v_cvt_pk_bf16_f32 v146, v140, v141
  v_cvt_pk_bf16_f32 v147, v142, v143
  ds_write_b64 v31, v[146:147]
  buffer_load_dwordx4 a[156:159], v207, s[20:23], s41 offen offset:3072 sc1
  s_waitcnt lgkmcnt(0)
  s_barrier
  ds_read_b64 v[50:51], v32 offset:0
  ds_read_b64 v[52:53], v32 offset:512
  ds_read_b64 v[54:55], v32 offset:1024
  s_waitcnt vmcnt(11)
  v_mfma_f32_16x16x32_bf16 v[68:71], a[0:3], a[96:99], 0
  buffer_load_dwordx4 a[112:115], v208, s[20:23], s40 offen offset:0 sc1
  v_mfma_f32_16x16x32_bf16 v[72:75], a[24:27], a[96:99], 0
  v_mfma_f32_16x16x32_bf16 v[76:79], a[48:51], a[96:99], 0
  s_waitcnt vmcnt(11)
  v_mfma_f32_16x16x32_bf16 v[80:83], a[0:3], a[120:123], 0
  buffer_load_dwordx4 a[136:139], v209, s[20:23], s40 offen offset:2048 sc1
  v_mfma_f32_16x16x32_bf16 v[84:87], a[24:27], a[120:123], 0
  v_mfma_f32_16x16x32_bf16 v[88:91], a[48:51], a[120:123], 0
  s_waitcnt vmcnt(11)
  v_mfma_f32_16x16x32_bf16 v[92:95], a[0:3], a[144:147], 0
  buffer_load_dwordx4 a[160:163], v208, s[20:23], s41 offen offset:0 sc1
  v_mfma_f32_16x16x32_bf16 v[96:99], a[24:27], a[144:147], 0
  v_mfma_f32_16x16x32_bf16 v[100:103], a[48:51], a[144:147], 0
  s_waitcnt vmcnt(11)
  v_mfma_f32_16x16x32_bf16 v[68:71], a[4:7], a[100:103], v[68:71]
  buffer_load_dwordx4 a[116:119], v208, s[20:23], s40 offen offset:1024 sc1
  v_mfma_f32_16x16x32_bf16 v[72:75], a[28:31], a[100:103], v[72:75]
  v_mfma_f32_16x16x32_bf16 v[76:79], a[52:55], a[100:103], v[76:79]
  s_waitcnt vmcnt(11)
  v_mfma_f32_16x16x32_bf16 v[80:83], a[4:7], a[124:127], v[80:83]
  buffer_load_dwordx4 a[140:143], v209, s[20:23], s40 offen offset:3072 sc1
  v_mfma_f32_16x16x32_bf16 v[84:87], a[28:31], a[124:127], v[84:87]
  v_mfma_f32_16x16x32_bf16 v[88:91], a[52:55], a[124:127], v[88:91]
  s_waitcnt vmcnt(11)
  v_mfma_f32_16x16x32_bf16 v[92:95], a[4:7], a[148:151], v[92:95]
  buffer_load_dwordx4 a[164:167], v208, s[20:23], s41 offen offset:1024 sc1
  v_mfma_f32_16x16x32_bf16 v[96:99], a[28:31], a[148:151], v[96:99]
  v_mfma_f32_16x16x32_bf16 v[100:103], a[52:55], a[148:151], v[100:103]
  s_waitcnt vmcnt(11)
  v_mfma_f32_16x16x32_bf16 v[68:71], a[8:11], a[104:107], v[68:71]
  v_mfma_f32_16x16x32_bf16 v[72:75], a[32:35], a[104:107], v[72:75]
  v_mfma_f32_16x16x32_bf16 v[76:79], a[56:59], a[104:107], v[76:79]
  s_waitcnt vmcnt(10)
  v_mfma_f32_16x16x32_bf16 v[80:83], a[8:11], a[128:131], v[80:83]
  v_mfma_f32_16x16x32_bf16 v[84:87], a[32:35], a[128:131], v[84:87]
  v_mfma_f32_16x16x32_bf16 v[88:91], a[56:59], a[128:131], v[88:91]
  s_waitcnt vmcnt(9)
  v_mfma_f32_16x16x32_bf16 v[92:95], a[8:11], a[152:155], v[92:95]
  v_mfma_f32_16x16x32_bf16 v[96:99], a[32:35], a[152:155], v[96:99]
  v_mfma_f32_16x16x32_bf16 v[100:103], a[56:59], a[152:155], v[100:103]
  s_waitcnt vmcnt(8)
  v_mfma_f32_16x16x32_bf16 v[68:71], a[12:15], a[108:111], v[68:71]
  v_mfma_f32_16x16x32_bf16 v[72:75], a[36:39], a[108:111], v[72:75]
  v_mfma_f32_16x16x32_bf16 v[76:79], a[60:63], a[108:111], v[76:79]
  s_waitcnt vmcnt(7)
  v_mfma_f32_16x16x32_bf16 v[80:83], a[12:15], a[132:135], v[80:83]
  v_mfma_f32_16x16x32_bf16 v[84:87], a[36:39], a[132:135], v[84:87]
  v_mfma_f32_16x16x32_bf16 v[88:91], a[60:63], a[132:135], v[88:91]
  s_waitcnt vmcnt(6)
  v_mfma_f32_16x16x32_bf16 v[92:95], a[12:15], a[156:159], v[92:95]
  v_mfma_f32_16x16x32_bf16 v[96:99], a[36:39], a[156:159], v[96:99]
  v_mfma_f32_16x16x32_bf16 v[100:103], a[60:63], a[156:159], v[100:103]
  s_waitcnt vmcnt(5)
  v_mfma_f32_16x16x32_bf16 v[68:71], a[16:19], a[112:115], v[68:71]
  v_mfma_f32_16x16x32_bf16 v[72:75], a[40:43], a[112:115], v[72:75]
  v_mfma_f32_16x16x32_bf16 v[76:79], a[64:67], a[112:115], v[76:79]
  s_waitcnt vmcnt(4)
  v_mfma_f32_16x16x32_bf16 v[80:83], a[16:19], a[136:139], v[80:83]
  v_mfma_f32_16x16x32_bf16 v[84:87], a[40:43], a[136:139], v[84:87]
  v_mfma_f32_16x16x32_bf16 v[88:91], a[64:67], a[136:139], v[88:91]
  s_waitcnt vmcnt(3)
  v_mfma_f32_16x16x32_bf16 v[92:95], a[16:19], a[160:163], v[92:95]
  v_mfma_f32_16x16x32_bf16 v[96:99], a[40:43], a[160:163], v[96:99]
  v_mfma_f32_16x16x32_bf16 v[100:103], a[64:67], a[160:163], v[100:103]
  s_waitcnt vmcnt(2)
  v_mfma_f32_16x16x32_bf16 v[68:71], a[20:23], a[116:119], v[68:71]
  v_mfma_f32_16x16x32_bf16 v[72:75], a[44:47], a[116:119], v[72:75]
  v_mfma_f32_16x16x32_bf16 v[76:79], a[68:71], a[116:119], v[76:79]
  s_waitcnt vmcnt(1)
  v_mfma_f32_16x16x32_bf16 v[80:83], a[20:23], a[140:143], v[80:83]
  v_mfma_f32_16x16x32_bf16 v[84:87], a[44:47], a[140:143], v[84:87]
  v_mfma_f32_16x16x32_bf16 v[88:91], a[68:71], a[140:143], v[88:91]
  s_waitcnt vmcnt(0)
  v_mfma_f32_16x16x32_bf16 v[92:95], a[20:23], a[164:167], v[92:95]
  v_mfma_f32_16x16x32_bf16 v[96:99], a[44:47], a[164:167], v[96:99]
  v_mfma_f32_16x16x32_bf16 v[100:103], a[68:71], a[164:167], v[100:103]
  v_cvt_pk_bf16_f32 v176, v68, v69
  v_cvt_pk_bf16_f32 v177, v70, v71
  v_cvt_pk_bf16_f32 v178, v80, v81
  v_cvt_pk_bf16_f32 v179, v82, v83
  s_nop 1
  v_cvt_pk_bf16_f32 v180, v92, v93
  v_cvt_pk_bf16_f32 v181, v94, v95
  s_waitcnt lgkmcnt(2)
  v_mfma_f32_16x16x16_bf16 v[220:223], v[176:177], v[50:51], v[220:223]
  v_mfma_f32_16x16x16_bf16 v[232:235], v[178:179], v[50:51], v[232:235]
  v_mfma_f32_16x16x16_bf16 v[244:247], v[180:181], v[50:51], v[244:247]
  v_cvt_pk_bf16_f32 v182, v72, v73
  v_cvt_pk_bf16_f32 v183, v74, v75
  v_cvt_pk_bf16_f32 v184, v84, v85
  v_cvt_pk_bf16_f32 v185, v86, v87
  v_cvt_pk_bf16_f32 v186, v96, v97
  v_cvt_pk_bf16_f32 v187, v98, v99
  s_waitcnt lgkmcnt(1)
  v_mfma_f32_16x16x16_bf16 v[224:227], v[182:183], v[52:53], v[224:227]
  v_mfma_f32_16x16x16_bf16 v[236:239], v[184:185], v[52:53], v[236:239]
  v_mfma_f32_16x16x16_bf16 v[248:251], v[186:187], v[52:53], v[248:251]
  v_cvt_pk_bf16_f32 v188, v76, v77
  v_cvt_pk_bf16_f32 v189, v78, v79
  v_cvt_pk_bf16_f32 v190, v88, v89
  v_cvt_pk_bf16_f32 v191, v90, v91
  v_cvt_pk_bf16_f32 v192, v100, v101
  v_cvt_pk_bf16_f32 v193, v102, v103
  s_waitcnt lgkmcnt(0)
  v_mfma_f32_16x16x16_bf16 v[228:231], v[188:189], v[54:55], v[228:231]
  v_mfma_f32_16x16x16_bf16 v[240:243], v[190:191], v[54:55], v[240:243]
  v_mfma_f32_16x16x16_bf16 v[252:255], v[192:193], v[54:55], v[252:255]
  v_pk_add_f32 v[194:195], v[220:221], v[222:223]
  v_pk_mul_f32 v[200:201], v[220:221], v[220:221]
  v_pk_add_f32 v[196:197], v[224:225], v[226:227]
  v_pk_mul_f32 v[202:203], v[224:225], v[224:225]
  s_nop 1
  v_pk_add_f32 v[198:199], v[228:229], v[230:231]
  v_pk_mul_f32 v[204:205], v[228:229], v[228:229]
  v_pk_fma_f32 v[200:201], v[222:223], v[222:223], v[200:201]
  v_pk_fma_f32 v[202:203], v[226:227], v[226:227], v[202:203]
  v_pk_fma_f32 v[204:205], v[230:231], v[230:231], v[204:205]
  v_pk_add_f32 v[194:195], v[194:195], v[232:233]
  v_pk_fma_f32 v[200:201], v[232:233], v[232:233], v[200:201]
  v_pk_add_f32 v[196:197], v[196:197], v[236:237]
  v_pk_fma_f32 v[202:203], v[236:237], v[236:237], v[202:203]
  v_pk_add_f32 v[198:199], v[198:199], v[240:241]
  v_pk_fma_f32 v[204:205], v[240:241], v[240:241], v[204:205]
  v_pk_add_f32 v[194:195], v[194:195], v[234:235]
  v_pk_fma_f32 v[200:201], v[234:235], v[234:235], v[200:201]
  v_pk_add_f32 v[196:197], v[196:197], v[238:239]
  v_pk_fma_f32 v[202:203], v[238:239], v[238:239], v[202:203]
  v_pk_add_f32 v[198:199], v[198:199], v[242:243]
  v_pk_fma_f32 v[204:205], v[242:243], v[242:243], v[204:205]
  v_pk_add_f32 v[194:195], v[194:195], v[244:245]
  v_pk_fma_f32 v[200:201], v[244:245], v[244:245], v[200:201]
  v_pk_add_f32 v[196:197], v[196:197], v[248:249]
  v_pk_fma_f32 v[202:203], v[248:249], v[248:249], v[202:203]
  v_pk_add_f32 v[198:199], v[198:199], v[252:253]
  v_pk_fma_f32 v[204:205], v[252:253], v[252:253], v[204:205]
  v_pk_add_f32 v[194:195], v[194:195], v[246:247]
  v_pk_fma_f32 v[200:201], v[246:247], v[246:247], v[200:201]
  v_pk_add_f32 v[196:197], v[196:197], v[250:251]
  v_pk_fma_f32 v[202:203], v[250:251], v[250:251], v[202:203]
  v_pk_add_f32 v[198:199], v[198:199], v[254:255]
  v_pk_fma_f32 v[204:205], v[254:255], v[254:255], v[204:205]
  v_add_f32 v194, v194, v195
  v_add_f32 v200, v200, v201
  v_add_f32 v196, v196, v197
  v_add_f32 v202, v202, v203
  v_add_f32 v198, v198, v199
  v_add_f32 v204, v204, v205
  v_permlane32_swap_b32 v194, v200
  v_permlane32_swap_b32 v196, v202
  v_permlane32_swap_b32 v198, v204
  v_add_f32 v194, v194, v200
  v_add_f32 v196, v196, v202
  v_add_f32 v198, v198, v204
  v_mov_b32 v195, v198
  v_permlane16_swap_b32 v194, v196
  s_nop 0
  v_permlane16_swap_b32 v198, v195
  v_add_f32 v194, v194, v196
  v_add_f32 v198, v198, v195
  ds_write_b32 v38, v194
  ds_write_b32 v39, v198
  s_waitcnt lgkmcnt(0)
  s_barrier
  ds_read_b128 v[68:71], v40 offset:0
  ds_read_b128 v[72:75], v40 offset:256
  ds_read_b128 v[76:79], v40 offset:512
  ds_read_b128 v[80:83], v40 offset:768
  ds_read_b128 v[84:87], v40 offset:1024
  ds_read_b128 v[88:91], v40 offset:1280
  s_waitcnt lgkmcnt(5)
  v_pk_add_f32 v[68:69], v[68:69], v[70:71]
  s_waitcnt lgkmcnt(4)
  v_pk_add_f32 v[72:73], v[72:73], v[74:75]
  s_waitcnt lgkmcnt(3)
  v_pk_add_f32 v[76:77], v[76:77], v[78:79]
  v_add_f32 v194, v68, v69
  v_add_f32 v196, v72, v73
  v_add_f32 v198, v76, v77
  s_waitcnt lgkmcnt(2)
  v_pk_add_f32 v[80:81], v[80:81], v[82:83]
  s_waitcnt lgkmcnt(1)
  v_pk_add_f32 v[84:85], v[84:85], v[86:87]
  s_waitcnt lgkmcnt(0)
  v_pk_add_f32 v[88:89], v[88:89], v[90:91]
  v_add_f32 v200, v80, v81
  v_add_f32 v202, v84, v85
  v_add_f32 v204, v88, v89
  v_mul_f32 v194, s38, v194
  v_mul_f32 v196, s38, v196
  v_mul_f32 v198, s38, v198
  v_mov_b32 v140, v194
  v_mov_b32 v142, v196
  v_mov_b32 v144, v198
  v_mul_f32 v4, v194, v194
  v_mul_f32 v5, v196, v196
  v_mul_f32 v6, v198, v198
  v_fma_f32 v200, v200, s38, -v4
  v_fma_f32 v202, v202, s38, -v5
  v_fma_f32 v204, v204, s38, -v6
  v_max_f32 v200, 0, v200
  v_max_f32 v202, 0, v202
  v_max_f32 v204, 0, v204
  v_add_f32 v200, 925353388, v200
  v_add_f32 v202, 925353388, v202
  v_add_f32 v204, 925353388, v204
  v_mov_b32 v141, v200
  v_mov_b32 v143, v202
  v_mov_b32 v145, v204
  v_rsq_f32 v200, v200
  v_rsq_f32 v202, v202
  v_rsq_f32 v204, v204
  v_mul_f32 v141, v141, v200
  v_mul_f32 v143, v143, v202
  v_mul_f32 v145, v145, v204
  v_mul_f32_e64 v194, -v194, v200
  v_mul_f32_e64 v196, -v196, v202
  v_mul_f32_e64 v198, -v198, v204
  s_cmp_eq_u32 s24, 1
  s_cselect_b64 vcc, -1, 0
  v_cndmask_b32 v140, v140, v142, vcc
  v_cndmask_b32 v141, v141, v143, vcc
  s_cmp_eq_u32 s24, 2
  s_cselect_b64 vcc, -1, 0
  v_cndmask_b32 v140, v140, v144, vcc
  v_cndmask_b32 v141, v141, v145, vcc
  buffer_store_dwordx2 v[140:141], v48, s[20:23], 0 offen sc1
  v_pk_fma_f32 v[220:221], v[220:221], v[200:201], v[194:195] op_sel_hi:[1,0,0]
  v_pk_fma_f32 v[222:223], v[222:223], v[200:201], v[194:195] op_sel_hi:[1,0,0]
  v_pk_fma_f32 v[232:233], v[232:233], v[200:201], v[194:195] op_sel_hi:[1,0,0]
  v_pk_fma_f32 v[234:235], v[234:235], v[200:201], v[194:195] op_sel_hi:[1,0,0]
  v_pk_fma_f32 v[244:245], v[244:245], v[200:201], v[194:195] op_sel_hi:[1,0,0]
  v_pk_fma_f32 v[246:247], v[246:247], v[200:201], v[194:195] op_sel_hi:[1,0,0]
  v_cvt_pk_bf16_f32 v176, v220, v221
  v_cvt_pk_bf16_f32 v177, v222, v223
  ds_write_b64 v41, v[176:177] offset:0
  v_cvt_pk_bf16_f32 v178, v232, v233
  v_cvt_pk_bf16_f32 v179, v234, v235
  ds_write_b64 v42, v[178:179] offset:0
  v_cvt_pk_bf16_f32 v180, v244, v245
  v_cvt_pk_bf16_f32 v181, v246, v247
  ds_write_b64 v43, v[180:181] offset:0
  v_pk_fma_f32 v[224:225], v[224:225], v[202:203], v[196:197] op_sel_hi:[1,0,0]
  v_pk_fma_f32 v[226:227], v[226:227], v[202:203], v[196:197] op_sel_hi:[1,0,0]
  v_pk_fma_f32 v[236:237], v[236:237], v[202:203], v[196:197] op_sel_hi:[1,0,0]
  v_pk_fma_f32 v[238:239], v[238:239], v[202:203], v[196:197] op_sel_hi:[1,0,0]
  v_pk_fma_f32 v[248:249], v[248:249], v[202:203], v[196:197] op_sel_hi:[1,0,0]
  v_pk_fma_f32 v[250:251], v[250:251], v[202:203], v[196:197] op_sel_hi:[1,0,0]
  v_cvt_pk_bf16_f32 v182, v224, v225
  v_cvt_pk_bf16_f32 v183, v226, v227
  ds_write_b64 v41, v[182:183] offset:6144
  v_cvt_pk_bf16_f32 v184, v236, v237
  v_cvt_pk_bf16_f32 v185, v238, v239
  ds_write_b64 v42, v[184:185] offset:6144
  v_cvt_pk_bf16_f32 v186, v248, v249
  v_cvt_pk_bf16_f32 v187, v250, v251
  ds_write_b64 v43, v[186:187] offset:6144
  v_pk_fma_f32 v[228:229], v[228:229], v[204:205], v[198:199] op_sel_hi:[1,0,0]
  v_pk_fma_f32 v[230:231], v[230:231], v[204:205], v[198:199] op_sel_hi:[1,0,0]
  v_pk_fma_f32 v[240:241], v[240:241], v[204:205], v[198:199] op_sel_hi:[1,0,0]
  v_pk_fma_f32 v[242:243], v[242:243], v[204:205], v[198:199] op_sel_hi:[1,0,0]
  v_pk_fma_f32 v[252:253], v[252:253], v[204:205], v[198:199] op_sel_hi:[1,0,0]
  v_pk_fma_f32 v[254:255], v[254:255], v[204:205], v[198:199] op_sel_hi:[1,0,0]
  v_cvt_pk_bf16_f32 v188, v228, v229
  v_cvt_pk_bf16_f32 v189, v230, v231
  ds_write_b64 v41, v[188:189] offset:12288
  v_cvt_pk_bf16_f32 v190, v240, v241
  v_cvt_pk_bf16_f32 v191, v242, v243
  ds_write_b64 v42, v[190:191] offset:12288
  v_cvt_pk_bf16_f32 v192, v252, v253
  v_cvt_pk_bf16_f32 v193, v254, v255
  ds_write_b64 v43, v[192:193] offset:12288
  s_waitcnt lgkmcnt(0)
  s_barrier
  ds_read_b128 v[68:71], v44 offset:0
  ds_read_b128 v[72:75], v44 offset:1024
  ds_read_b128 v[76:79], v44 offset:2048
  ds_read_b128 v[80:83], v45 offset:0
  ds_read_b128 v[84:87], v45 offset:1024
  ds_read_b128 v[88:91], v45 offset:2048
  s_waitcnt lgkmcnt(5)
  buffer_store_dwordx4 v[68:71], v46, s[20:23], 0 offen sc1
  s_waitcnt lgkmcnt(4)
  buffer_store_dwordx4 v[72:75], v46, s[20:23], s34 offen sc1
  s_waitcnt lgkmcnt(3)
  buffer_store_dwordx4 v[76:79], v46, s[20:23], s35 offen sc1
  s_waitcnt lgkmcnt(2)
  buffer_store_dwordx4 v[80:83], v47, s[20:23], 0 offen sc1
  s_waitcnt lgkmcnt(1)
  buffer_store_dwordx4 v[84:87], v47, s[20:23], s34 offen sc1
  s_waitcnt lgkmcnt(0)
  buffer_store_dwordx4 v[88:91], v47, s[20:23], s35 offen sc1
  s_endpgm
LA_wspin:
  s_mov_b32 s94, 0
LA_wspin1:
  s_sleep 4
  buffer_load_dword v206, off, s[52:55], 0 offset:128 sc1
  s_add_u32 s94, s94, 1
  s_waitcnt vmcnt(0)
  v_readfirstlane_b32 s26, v206
  s_cmp_ge_u32 s94, 0x40000
  s_cbranch_scc1 LA_wok
  s_nop 4
  s_cmp_eq_u32 s26, 0
  s_cbranch_scc1 LA_wspin1
  s_branch LA_wok
LA_spare:
  s_cmp_lt_u32 s2, 18
  s_cbranch_scc1 LS_vt
  s_cmp_lt_u32 s2, 30
  s_cbranch_scc1 LS_qk
  s_branch LS_vs
LS_vt:
  s_load_dwordx2 s[12:13], s[0:1], 8
  s_load_dwordx2 s[16:17], s[0:1], 16
  s_load_dwordx2 s[20:21], s[0:1], 56
  s_load_dwordx2 s[52:53], s[0:1], 48
  s_mov_b32 s54, 256
  s_mov_b32 s55, 0x00020000
  v_lshrrev_b32 v4, 6, v0
  v_and_b32 v1, 63, v0
  v_readfirstlane_b32 s24, v4
  v_lshrrev_b32 v2, 4, v1
  v_and_b32 v3, 15, v1
  v_lshlrev_b32 v13, 4, v1
  s_mov_b32 s14, 221184
  s_mov_b32 s15, 0x00020000
  s_mov_b32 s18, 73728
  s_mov_b32 s19, 0x00020000
  s_mov_b32 s22, 16777216
  s_mov_b32 s23, 0x00020000
  s_mul_hi_u32 s30, s2, 1431655766
  s_mul_i32 s26, s30, 3
  s_sub_u32 s29, s2, s26
  v_lshrrev_b32 v4, 3, v1
  v_and_b32 v5, 7, v1
  v_mul_u32_u24 v11, 384, v4
  v_lshl_add_u32 v11, v5, 4, v11
  v_bfe_u32 v6, v1, 4, 2
  v_lshlrev_b32 v6, 1, v6
  v_xor_b32 v6, v6, v5
  v_mul_u32_u24 v9, 1152, v4
  v_lshl_add_u32 v9, v6, 4, v9
  s_lshl_b32 s26, s30, 5
  s_lshl_b32 s27, s24, 3
  s_add_u32 s26, s26, s27
  s_mul_i32 s26, s26, 1152
  s_add_u32 s26, s26, 768
  s_mul_i32 s27, s24, 3072
  s_add_u32 m0, s27, 24576
  s_waitcnt lgkmcnt(0)
  buffer_load_dwordx4 v9, s[12:15], s26 offen offset:0 lds
  s_add_u32 m0, s27, 25472
  s_nop 0
  buffer_load_dwordx4 v9, s[12:15], s26 offen offset:128 lds
  s_add_u32 m0, s27, 26368
  s_nop 0
  buffer_load_dwordx4 v9, s[12:15], s26 offen offset:256 lds
  s_mul_i32 s26, s24, 3072
  s_lshl_b32 s27, s29, 7
  s_add_u32 s26, s26, s27
  s_lshl_b32 s27, s24, 10
  s_add_u32 m0, s27, 0
  s_nop 0
  buffer_load_dwordx4 v11, s[16:19], s26 offen lds
  s_add_u32 m0, s27, 4096
  s_add_u32 s26, s26, 12288
  buffer_load_dwordx4 v11, s[16:19], s26 offen lds
  s_add_u32 m0, s27, 8192
  s_add_u32 s26, s26, 12288
  buffer_load_dwordx4 v11, s[16:19], s26 offen lds
  s_add_u32 m0, s27, 12288
  s_add_u32 s26, s26, 12288
  buffer_load_dwordx4 v11, s[16:19], s26 offen lds
  s_add_u32 m0, s27, 16384
  s_add_u32 s26, s26, 12288
  buffer_load_dwordx4 v11, s[16:19], s26 offen lds
  s_add_u32 m0, s27, 20480
  s_add_u32 s26, s26, 12288
  buffer_load_dwordx4 v11, s[16:19], s26 offen lds
  v_lshrrev_b32 v4, 2, v3
  v_lshl_add_u32 v4, v2, 3, v4
  v_lshlrev_b32 v4, 7, v4
  v_and_b32 v5, 3, v3
  v_lshl_add_u32 v4, v5, 3, v4
  s_lshl_b32 s26, s24, 5
  v_add_u32 v12, s26, v4
  v_lshrrev_b32 v4, 3, v3
  v_mul_u32_u24 v4, 3072, v4
  v_and_b32 v5, 7, v3
  v_lshl_add_u32 v4, v5, 7, v4
  v_bfe_u32 v5, v3, 1, 2
  v_lshlrev_b32 v5, 1, v5
  v_xor_b32 v5, v5, v2
  v_lshl_add_u32 v9, v5, 4, v4
  v_add_u32 v9, 24576, v9
  v_xor_b32 v10, 64, v9
  s_lshl_b32 s26, s29, 2
  s_add_u32 s26, s26, s24
  s_mul_i32 s26, s26, 6
  s_add_u32 s26, s26, s30
  s_lshl_b32 s32, s26, 10
  s_add_u32 s32, s32, 9175040
  s_waitcnt vmcnt(0)
  s_barrier
  ds_read_b128 v[16:19], v9 offset:0
  ds_read_b128 v[20:23], v9 offset:6144
  ds_read_b64_tr_b16 v[64:65], v12 offset:0
  ds_read_b64_tr_b16 v[66:67], v12 offset:512
  ds_read_b128 v[24:27], v10 offset:0
  ds_read_b128 v[28:31], v10 offset:6144
  ds_read_b64_tr_b16 v[68:69], v12 offset:4096
  ds_read_b64_tr_b16 v[70:71], v12 offset:4608
  ds_read_b128 v[32:35], v9 offset:1024
  ds_read_b128 v[36:39], v9 offset:7168
  ds_read_b64_tr_b16 v[72:73], v12 offset:8192
  ds_read_b64_tr_b16 v[74:75], v12 offset:8704
  ds_read_b128 v[40:43], v10 offset:1024
  ds_read_b128 v[44:47], v10 offset:7168
  ds_read_b64_tr_b16 v[76:77], v12 offset:12288
  ds_read_b64_tr_b16 v[78:79], v12 offset:12800
  ds_read_b128 v[48:51], v9 offset:2048
  ds_read_b128 v[52:55], v9 offset:8192
  ds_read_b64_tr_b16 v[80:81], v12 offset:16384
  ds_read_b64_tr_b16 v[82:83], v12 offset:16896
  ds_read_b128 v[56:59], v10 offset:2048
  ds_read_b128 v[60:63], v10 offset:8192
  ds_read_b64_tr_b16 v[84:85], v12 offset:20480
  ds_read_b64_tr_b16 v[86:87], v12 offset:20992
  s_waitcnt lgkmcnt(14)
  v_mfma_f32_16x16x32_bf16 v[90:93], v[16:19], v[64:67], 0
  v_mfma_f32_16x16x32_bf16 v[94:97], v[20:23], v[64:67], 0
  v_mfma_f32_16x16x32_bf16 v[90:93], v[24:27], v[68:71], v[90:93]
  v_mfma_f32_16x16x32_bf16 v[94:97], v[28:31], v[68:71], v[94:97]
  s_waitcnt lgkmcnt(12)
  v_mfma_f32_16x16x32_bf16 v[90:93], v[32:35], v[72:75], v[90:93]
  v_mfma_f32_16x16x32_bf16 v[94:97], v[36:39], v[72:75], v[94:97]
  s_waitcnt lgkmcnt(8)
  v_mfma_f32_16x16x32_bf16 v[90:93], v[40:43], v[76:79], v[90:93]
  v_mfma_f32_16x16x32_bf16 v[94:97], v[44:47], v[76:79], v[94:97]
  s_waitcnt lgkmcnt(4)
  v_mfma_f32_16x16x32_bf16 v[90:93], v[48:51], v[80:83], v[90:93]
  v_mfma_f32_16x16x32_bf16 v[94:97], v[52:55], v[80:83], v[94:97]
  s_waitcnt lgkmcnt(0)
  v_mfma_f32_16x16x32_bf16 v[90:93], v[56:59], v[84:87], v[90:93]
  v_mfma_f32_16x16x32_bf16 v[94:97], v[60:63], v[84:87], v[94:97]
  s_nop 6
  v_cvt_pk_bf16_f32 v90, v90, v91
  v_cvt_pk_bf16_f32 v91, v92, v93
  v_cvt_pk_bf16_f32 v92, v94, v95
  v_cvt_pk_bf16_f32 v93, v96, v97
  buffer_store_dwordx4 v[90:93], v13, s[20:23], s32 offen sc1
  s_waitcnt vmcnt(0)
  s_barrier
  s_cmp_lg_u32 s24, 0
  s_cbranch_scc1 LA_end
  v_mov_b32 v4, 1
  v_mov_b32 v5, 0
  s_mov_b64 exec, 1
  buffer_atomic_add v4, v5, s[52:55], 0 offen sc0
  s_waitcnt vmcnt(0)
  v_readfirstlane_b32 s26, v4
  v_mov_b32 v4, 1
  s_nop 3
  s_cmp_lg_u32 s26, 17
  s_cbranch_scc1 LS_vt_done
  buffer_store_dword v4, off, s[52:55], 0 offset:128 sc1
LS_vt_done:
  s_mov_b64 exec, -1
  s_endpgm
LS_qk:
  s_load_dwordx2 s[12:13], s[0:1], 24
  s_load_dwordx2 s[20:21], s[0:1], 56
  v_lshrrev_b32 v4, 6, v0
  v_and_b32 v1, 63, v0
  v_readfirstlane_b32 s24, v4
  v_lshrrev_b32 v2, 4, v1
  v_and_b32 v3, 15, v1
  v_lshlrev_b32 v13, 4, v1
  s_mov_b32 s14, 221184
  s_mov_b32 s15, 0x00020000
  s_mov_b32 s18, 73728
  s_mov_b32 s19, 0x00020000
  s_mov_b32 s22, 16777216
  s_mov_b32 s23, 0x00020000
  s_sub_u32 s29, s2, 18
  v_lshrrev_b32 v4, 2, v3
  v_lshlrev_b32 v4, 3, v4
  v_and_b32 v5, 3, v3
  v_add_u32 v4, v4, v5
  s_lshr_b32 s26, s29, 1
  s_lshl_b32 s26, s26, 5
  s_and_b32 s27, s29, 1
  s_lshl_b32 s27, s27, 2
  s_add_u32 s26, s26, s27
  v_add_u32 v5, s26, v4
  v_mul_u32_u24 v11, 1152, v5
  v_lshl_add_u32 v11, v2, 4, v11
  s_mul_i32 s32, s29, 6144
  s_add_u32 s32, s32, 8388608
  s_mov_b32 s33, 1037384597
  s_waitcnt lgkmcnt(0)
  buffer_load_dwordx4 v[112:115], v11, s[12:15], 0 offen offset:384
  buffer_load_dwordx4 v[116:119], v11, s[12:15], 0 offen offset:448
  buffer_load_dwordx4 v[120:123], v11, s[12:15], 0 offen offset:512
  buffer_load_dwordx4 v[124:127], v11, s[12:15], 0 offen offset:576
  buffer_load_dwordx4 v[128:131], v11, s[12:15], 0 offen offset:640
  buffer_load_dwordx4 v[132:135], v11, s[12:15], 0 offen offset:704
  s_mov_b32 s30, s24
  s_lshl_b32 s26, s30, 5
  v_add_u32 v5, s26, v4
  v_mul_u32_u24 v9, 1152, v5
  v_lshl_add_u32 v9, v2, 4, v9
  v_add_u32 v10, 4608, v9
  buffer_load_dwordx4 v[16:19], v9, s[12:15], 0 offen offset:0
  buffer_load_dwordx4 v[20:23], v10, s[12:15], 0 offen offset:0
  buffer_load_dwordx4 v[24:27], v9, s[12:15], 0 offen offset:64
  buffer_load_dwordx4 v[28:31], v10, s[12:15], 0 offen offset:64
  buffer_load_dwordx4 v[32:35], v9, s[12:15], 0 offen offset:128
  buffer_load_dwordx4 v[36:39], v10, s[12:15], 0 offen offset:128
  buffer_load_dwordx4 v[40:43], v9, s[12:15], 0 offen offset:192
  buffer_load_dwordx4 v[44:47], v10, s[12:15], 0 offen offset:192
  buffer_load_dwordx4 v[48:51], v9, s[12:15], 0 offen offset:256
  buffer_load_dwordx4 v[52:55], v10, s[12:15], 0 offen offset:256
  buffer_load_dwordx4 v[56:59], v9, s[12:15], 0 offen offset:320
  buffer_load_dwordx4 v[60:63], v10, s[12:15], 0 offen offset:320
  s_and_b32 s30, s24, 1
  s_add_u32 s30, s30, 4
  s_lshl_b32 s26, s30, 5
  v_add_u32 v5, s26, v4
  v_mul_u32_u24 v9, 1152, v5
  v_lshl_add_u32 v9, v2, 4, v9
  v_add_u32 v10, 4608, v9
  buffer_load_dwordx4 v[64:67], v9, s[12:15], 0 offen offset:0
  buffer_load_dwordx4 v[68:71], v10, s[12:15], 0 offen offset:0
  buffer_load_dwordx4 v[72:75], v9, s[12:15], 0 offen offset:64
  buffer_load_dwordx4 v[76:79], v10, s[12:15], 0 offen offset:64
  buffer_load_dwordx4 v[80:83], v9, s[12:15], 0 offen offset:128
  buffer_load_dwordx4 v[84:87], v10, s[12:15], 0 offen offset:128
  buffer_load_dwordx4 v[88:91], v9, s[12:15], 0 offen offset:192
  buffer_load_dwordx4 v[92:95], v10, s[12:15], 0 offen offset:192
  buffer_load_dwordx4 v[96:99], v9, s[12:15], 0 offen offset:256
  buffer_load_dwordx4 v[100:103], v10, s[12:15], 0 offen offset:256
  buffer_load_dwordx4 v[104:107], v9, s[12:15], 0 offen offset:320
  buffer_load_dwordx4 v[108:111], v10, s[12:15], 0 offen offset:320
  s_waitcnt vmcnt(23)
  v_mfma_f32_16x16x32_bf16 v[140:143], v[16:19], v[112:115], 0
  s_waitcnt vmcnt(22)
  v_mfma_f32_16x16x32_bf16 v[144:147], v[20:23], v[112:115], 0
  s_waitcnt vmcnt(21)
  v_mfma_f32_16x16x32_bf16 v[140:143], v[24:27], v[116:119], v[140:143]
  s_waitcnt vmcnt(20)
  v_mfma_f32_16x16x32_bf16 v[144:147], v[28:31], v[116:119], v[144:147]
  s_waitcnt vmcnt(19)
  v_mfma_f32_16x16x32_bf16 v[140:143], v[32:35], v[120:123], v[140:143]
  s_waitcnt vmcnt(18)
  v_mfma_f32_16x16x32_bf16 v[144:147], v[36:39], v[120:123], v[144:147]
  s_waitcnt vmcnt(17)
  v_mfma_f32_16x16x32_bf16 v[140:143], v[40:43], v[124:127], v[140:143]
  s_waitcnt vmcnt(16)
  v_mfma_f32_16x16x32_bf16 v[144:147], v[44:47], v[124:127], v[144:147]
  s_waitcnt vmcnt(15)
  v_mfma_f32_16x16x32_bf16 v[140:143], v[48:51], v[128:131], v[140:143]
  s_waitcnt vmcnt(14)
  v_mfma_f32_16x16x32_bf16 v[144:147], v[52:55], v[128:131], v[144:147]
  s_waitcnt vmcnt(13)
  v_mfma_f32_16x16x32_bf16 v[140:143], v[56:59], v[132:135], v[140:143]
  s_waitcnt vmcnt(12)
  v_mfma_f32_16x16x32_bf16 v[144:147], v[60:63], v[132:135], v[144:147]
  s_nop 5
  v_mul_f32 v140, s33, v140
  v_mul_f32 v141, s33, v141
  v_mul_f32 v142, s33, v142
  v_mul_f32 v143, s33, v143
  v_mul_f32 v144, s33, v144
  v_mul_f32 v145, s33, v145
  v_mul_f32 v146, s33, v146
  v_mul_f32 v147, s33, v147
  v_cvt_pk_bf16_f32 v140, v140, v141
  v_cvt_pk_bf16_f32 v141, v142, v143
  v_cvt_pk_bf16_f32 v142, v144, v145
  v_cvt_pk_bf16_f32 v143, v146, v147
  s_lshl_b32 s26, s24, 10
  s_add_u32 s26, s26, s32
  buffer_store_dwordx4 v[140:143], v13, s[20:23], s26 offen sc1
  s_waitcnt vmcnt(12)
  v_mfma_f32_16x16x32_bf16 v[148:151], v[64:67], v[112:115], 0
  s_waitcnt vmcnt(11)
  v_mfma_f32_16x16x32_bf16 v[152:155], v[68:71], v[112:115], 0
  s_waitcnt vmcnt(10)
  v_mfma_f32_16x16x32_bf16 v[148:151], v[72:75], v[116:119], v[148:151]
  s_waitcnt vmcnt(9)
  v_mfma_f32_16x16x32_bf16 v[152:155], v[76:79], v[116:119], v[152:155]
  s_waitcnt vmcnt(8)
  v_mfma_f32_16x16x32_bf16 v[148:151], v[80:83], v[120:123], v[148:151]
  s_waitcnt vmcnt(7)
  v_mfma_f32_16x16x32_bf16 v[152:155], v[84:87], v[120:123], v[152:155]
  s_waitcnt vmcnt(6)
  v_mfma_f32_16x16x32_bf16 v[148:151], v[88:91], v[124:127], v[148:151]
  s_waitcnt vmcnt(5)
  v_mfma_f32_16x16x32_bf16 v[152:155], v[92:95], v[124:127], v[152:155]
  s_waitcnt vmcnt(4)
  v_mfma_f32_16x16x32_bf16 v[148:151], v[96:99], v[128:131], v[148:151]
  s_waitcnt vmcnt(3)
  v_mfma_f32_16x16x32_bf16 v[152:155], v[100:103], v[128:131], v[152:155]
  s_waitcnt vmcnt(2)
  v_mfma_f32_16x16x32_bf16 v[148:151], v[104:107], v[132:135], v[148:151]
  s_waitcnt vmcnt(1)
  v_mfma_f32_16x16x32_bf16 v[152:155], v[108:111], v[132:135], v[152:155]
  s_nop 5
  v_mul_f32 v148, s33, v148
  v_mul_f32 v149, s33, v149
  v_mul_f32 v150, s33, v150
  v_mul_f32 v151, s33, v151
  v_mul_f32 v152, s33, v152
  v_mul_f32 v153, s33, v153
  v_mul_f32 v154, s33, v154
  v_mul_f32 v155, s33, v155
  v_cvt_pk_bf16_f32 v148, v148, v149
  v_cvt_pk_bf16_f32 v149, v150, v151
  v_cvt_pk_bf16_f32 v150, v152, v153
  v_cvt_pk_bf16_f32 v151, v154, v155
  s_and_b32 s26, s24, 1
  s_add_u32 s26, s26, 4
  s_lshl_b32 s26, s26, 10
  s_cmp_ge_u32 s24, 2
  s_cselect_b32 s27, 0x7f000000, 0
  s_add_u32 s26, s26, s27
  s_add_u32 s26, s26, s32
  buffer_store_dwordx4 v[148:151], v13, s[20:23], s26 offen sc1
  s_endpgm
LS_vs:
  s_load_dwordx2 s[12:13], s[0:1], 24
  s_load_dwordx2 s[16:17], s[0:1], 32
  s_load_dwordx2 s[20:21], s[0:1], 56
  v_lshrrev_b32 v4, 6, v0
  v_and_b32 v1, 63, v0
  v_readfirstlane_b32 s24, v4
  v_lshrrev_b32 v2, 4, v1
  v_and_b32 v3, 15, v1
  v_lshlrev_b32 v13, 4, v1
  s_mov_b32 s14, 221184
  s_mov_b32 s15, 0x00020000
  s_mov_b32 s18, 73728
  s_mov_b32 s19, 0x00020000
  s_mov_b32 s22, 16777216
  s_mov_b32 s23, 0x00020000
  v_lshrrev_b32 v4, 2, v1
  v_mul_u32_u24 v4, 384, v4
  v_and_b32 v6, 3, v1
  v_lshl_add_u32 v11, v6, 4, v4
  s_sub_u32 s29, s2, 30
  s_lshl_b32 s29, s29, 1
  s_add_u32 s29, s29, 0
  s_mul_hi_u32 s26, s29, 1431655766
  s_mul_i32 s27, s26, 3
  s_sub_u32 s27, s29, s27
  s_mul_i32 s31, s26, 96
  s_lshl_b32 s26, s27, 3
  s_cmp_eq_u32 s27, 2
  s_cselect_b32 s28, 32, 0
  s_cselect_b32 s27, 3, 4
  s_cselect_b32 s26, 32, s26
  s_add_u32 s31, s31, s28
  v_and_b32 v5, 3, v3
  v_lshlrev_b32 v5, s27, v5
  v_add_u32 v5, s26, v5
  v_lshrrev_b32 v4, 2, v3
  v_lshl_add_u32 v4, v2, 3, v4
  v_lshl_add_u32 v12, v4, 6, v5
  s_mul_i32 s26, s24, 6144
  s_add_u32 s26, s26, s31
  s_lshl_b32 s28, s24, 10
  s_add_u32 m0, s28, 0
  s_waitcnt lgkmcnt(0)
  buffer_load_dwordx4 v11, s[16:19], s26 offen lds
  s_add_u32 m0, s28, 4096
  s_add_u32 s26, s26, 24576
  buffer_load_dwordx4 v11, s[16:19], s26 offen lds
  s_add_u32 m0, s28, 8192
  s_add_u32 s26, s26, 24576
  buffer_load_dwordx4 v11, s[16:19], s26 offen lds
  s_sub_u32 s29, s2, 30
  s_lshl_b32 s29, s29, 1
  s_add_u32 s29, s29, 1
  s_mul_hi_u32 s26, s29, 1431655766
  s_mul_i32 s27, s26, 3
  s_sub_u32 s27, s29, s27
  s_mul_i32 s31, s26, 96
  s_lshl_b32 s26, s27, 3
  s_cmp_eq_u32 s27, 2
  s_cselect_b32 s28, 32, 0
  s_cselect_b32 s27, 3, 4
  s_cselect_b32 s26, 32, s26
  s_add_u32 s31, s31, s28
  v_and_b32 v5, 3, v3
  v_lshlrev_b32 v5, s27, v5
  v_add_u32 v5, s26, v5
  v_lshrrev_b32 v4, 2, v3
  v_lshl_add_u32 v4, v2, 3, v4
  v_lshl_add_u32 v14, v4, 6, v5
  s_mul_i32 s26, s24, 6144
  s_add_u32 s26, s26, s31
  s_lshl_b32 s28, s24, 10
  s_add_u32 m0, s28, 12288
  s_nop 0
  buffer_load_dwordx4 v11, s[16:19], s26 offen lds
  s_add_u32 m0, s28, 16384
  s_add_u32 s26, s26, 24576
  buffer_load_dwordx4 v11, s[16:19], s26 offen lds
  s_add_u32 m0, s28, 20480
  s_add_u32 s26, s26, 24576
  buffer_load_dwordx4 v11, s[16:19], s26 offen lds
  s_mov_b32 s30, s24
  s_lshl_b32 s26, s30, 5
  v_add_u32 v4, s26, v3
  v_mul_u32_u24 v9, 1152, v4
  v_lshl_add_u32 v9, v2, 4, v9
  v_add_u32 v10, 18432, v9
  buffer_load_dwordx4 v[16:19], v9, s[12:15], 0 offen offset:768
  buffer_load_dwordx4 v[20:23], v10, s[12:15], 0 offen offset:768
  buffer_load_dwordx4 v[24:27], v9, s[12:15], 0 offen offset:832
  buffer_load_dwordx4 v[28:31], v10, s[12:15], 0 offen offset:832
  buffer_load_dwordx4 v[32:35], v9, s[12:15], 0 offen offset:896
  buffer_load_dwordx4 v[36:39], v10, s[12:15], 0 offen offset:896
  buffer_load_dwordx4 v[40:43], v9, s[12:15], 0 offen offset:960
  buffer_load_dwordx4 v[44:47], v10, s[12:15], 0 offen offset:960
  buffer_load_dwordx4 v[48:51], v9, s[12:15], 0 offen offset:1024
  buffer_load_dwordx4 v[52:55], v10, s[12:15], 0 offen offset:1024
  buffer_load_dwordx4 v[56:59], v9, s[12:15], 0 offen offset:1088
  buffer_load_dwordx4 v[60:63], v10, s[12:15], 0 offen offset:1088
  s_and_b32 s30, s24, 1
  s_add_u32 s30, s30, 4
  s_lshl_b32 s26, s30, 5
  v_add_u32 v4, s26, v3
  v_mul_u32_u24 v9, 1152, v4
  v_lshl_add_u32 v9, v2, 4, v9
  v_add_u32 v10, 18432, v9
  buffer_load_dwordx4 v[64:67], v9, s[12:15], 0 offen offset:768
  buffer_load_dwordx4 v[68:71], v10, s[12:15], 0 offen offset:768
  buffer_load_dwordx4 v[72:75], v9, s[12:15], 0 offen offset:832
  buffer_load_dwordx4 v[76:79], v10, s[12:15], 0 offen offset:832
  buffer_load_dwordx4 v[80:83], v9, s[12:15], 0 offen offset:896
  buffer_load_dwordx4 v[84:87], v10, s[12:15], 0 offen offset:896
  buffer_load_dwordx4 v[88:91], v9, s[12:15], 0 offen offset:960
  buffer_load_dwordx4 v[92:95], v10, s[12:15], 0 offen offset:960
  buffer_load_dwordx4 v[96:99], v9, s[12:15], 0 offen offset:1024
  buffer_load_dwordx4 v[100:103], v10, s[12:15], 0 offen offset:1024
  buffer_load_dwordx4 v[104:107], v9, s[12:15], 0 offen offset:1088
  buffer_load_dwordx4 v[108:111], v10, s[12:15], 0 offen offset:1088
  s_waitcnt vmcnt(24)
  s_barrier
  ds_read_b64_tr_b16 v[112:113], v12 offset:0
  ds_read_b64_tr_b16 v[114:115], v12 offset:256
  ds_read_b64_tr_b16 v[116:117], v12 offset:2048
  ds_read_b64_tr_b16 v[118:119], v12 offset:2304
  ds_read_b64_tr_b16 v[120:121], v12 offset:4096
  ds_read_b64_tr_b16 v[122:123], v12 offset:4352
  ds_read_b64_tr_b16 v[124:125], v12 offset:6144
  ds_read_b64_tr_b16 v[126:127], v12 offset:6400
  ds_read_b64_tr_b16 v[128:129], v12 offset:8192
  ds_read_b64_tr_b16 v[130:131], v12 offset:8448
  ds_read_b64_tr_b16 v[132:133], v12 offset:10240
  ds_read_b64_tr_b16 v[134:135], v12 offset:10496
  ds_read_b64_tr_b16 v[136:137], v14 offset:12288
  ds_read_b64_tr_b16 v[138:139], v14 offset:12544
  ds_read_b64_tr_b16 v[140:141], v14 offset:14336
  ds_read_b64_tr_b16 v[142:143], v14 offset:14592
  ds_read_b64_tr_b16 v[144:145], v14 offset:16384
  ds_read_b64_tr_b16 v[146:147], v14 offset:16640
  ds_read_b64_tr_b16 v[148:149], v14 offset:18432
  ds_read_b64_tr_b16 v[150:151], v14 offset:18688
  ds_read_b64_tr_b16 v[152:153], v14 offset:20480
  ds_read_b64_tr_b16 v[154:155], v14 offset:20736
  ds_read_b64_tr_b16 v[156:157], v14 offset:22528
  ds_read_b64_tr_b16 v[158:159], v14 offset:22784
  s_sub_u32 s29, s2, 30
  s_mul_i32 s32, s29, 12288
  s_add_u32 s32, s32, 9043968
  s_waitcnt vmcnt(23) lgkmcnt(14)
  v_mfma_f32_16x16x32_bf16 v[160:163], v[16:19], v[112:115], 0
  s_waitcnt vmcnt(22)
  v_mfma_f32_16x16x32_bf16 v[164:167], v[20:23], v[112:115], 0
  s_waitcnt vmcnt(21)
  v_mfma_f32_16x16x32_bf16 v[160:163], v[24:27], v[116:119], v[160:163]
  s_waitcnt vmcnt(20)
  v_mfma_f32_16x16x32_bf16 v[164:167], v[28:31], v[116:119], v[164:167]
  s_waitcnt vmcnt(19)
  v_mfma_f32_16x16x32_bf16 v[160:163], v[32:35], v[120:123], v[160:163]
  s_waitcnt vmcnt(18)
  v_mfma_f32_16x16x32_bf16 v[164:167], v[36:39], v[120:123], v[164:167]
  s_waitcnt vmcnt(17)
  v_mfma_f32_16x16x32_bf16 v[160:163], v[40:43], v[124:127], v[160:163]
  s_waitcnt vmcnt(16)
  v_mfma_f32_16x16x32_bf16 v[164:167], v[44:47], v[124:127], v[164:167]
  s_waitcnt vmcnt(15)
  v_mfma_f32_16x16x32_bf16 v[160:163], v[48:51], v[128:131], v[160:163]
  s_waitcnt vmcnt(14)
  v_mfma_f32_16x16x32_bf16 v[164:167], v[52:55], v[128:131], v[164:167]
  s_waitcnt vmcnt(13) lgkmcnt(12)
  v_mfma_f32_16x16x32_bf16 v[160:163], v[56:59], v[132:135], v[160:163]
  s_waitcnt vmcnt(12)
  v_mfma_f32_16x16x32_bf16 v[164:167], v[60:63], v[132:135], v[164:167]
  s_waitcnt lgkmcnt(10)
  v_mfma_f32_16x16x32_bf16 v[168:171], v[16:19], v[136:139], 0
  v_mfma_f32_16x16x32_bf16 v[172:175], v[20:23], v[136:139], 0
  s_waitcnt lgkmcnt(8)
  v_mfma_f32_16x16x32_bf16 v[168:171], v[24:27], v[140:143], v[168:171]
  v_mfma_f32_16x16x32_bf16 v[172:175], v[28:31], v[140:143], v[172:175]
  s_waitcnt lgkmcnt(6)
  v_mfma_f32_16x16x32_bf16 v[168:171], v[32:35], v[144:147], v[168:171]
  v_mfma_f32_16x16x32_bf16 v[172:175], v[36:39], v[144:147], v[172:175]
  s_waitcnt lgkmcnt(4)
  v_mfma_f32_16x16x32_bf16 v[168:171], v[40:43], v[148:151], v[168:171]
  v_mfma_f32_16x16x32_bf16 v[172:175], v[44:47], v[148:151], v[172:175]
  s_waitcnt lgkmcnt(2)
  v_mfma_f32_16x16x32_bf16 v[168:171], v[48:51], v[152:155], v[168:171]
  v_mfma_f32_16x16x32_bf16 v[172:175], v[52:55], v[152:155], v[172:175]
  s_waitcnt lgkmcnt(0)
  v_mfma_f32_16x16x32_bf16 v[168:171], v[56:59], v[156:159], v[168:171]
  v_mfma_f32_16x16x32_bf16 v[172:175], v[60:63], v[156:159], v[172:175]
  v_cvt_pk_bf16_f32 v160, v160, v161
  v_cvt_pk_bf16_f32 v161, v162, v163
  v_cvt_pk_bf16_f32 v162, v164, v165
  v_cvt_pk_bf16_f32 v163, v166, v167
  s_lshl_b32 s26, s24, 10
  s_add_u32 s26, s26, s32
  s_add_u32 s26, s26, 0
  buffer_store_dwordx4 v[160:163], v13, s[20:23], s26 offen sc1
  v_cvt_pk_bf16_f32 v168, v168, v169
  v_cvt_pk_bf16_f32 v169, v170, v171
  v_cvt_pk_bf16_f32 v170, v172, v173
  v_cvt_pk_bf16_f32 v171, v174, v175
  s_lshl_b32 s26, s24, 10
  s_add_u32 s26, s26, s32
  s_add_u32 s26, s26, 6144
  buffer_store_dwordx4 v[168:171], v13, s[20:23], s26 offen sc1
  s_waitcnt vmcnt(13)
  v_mfma_f32_16x16x32_bf16 v[176:179], v[64:67], v[112:115], 0
  s_waitcnt vmcnt(12)
  v_mfma_f32_16x16x32_bf16 v[180:183], v[68:71], v[112:115], 0
  s_waitcnt vmcnt(11)
  v_mfma_f32_16x16x32_bf16 v[176:179], v[72:75], v[116:119], v[176:179]
  s_waitcnt vmcnt(10)
  v_mfma_f32_16x16x32_bf16 v[180:183], v[76:79], v[116:119], v[180:183]
  s_waitcnt vmcnt(9)
  v_mfma_f32_16x16x32_bf16 v[176:179], v[80:83], v[120:123], v[176:179]
  s_waitcnt vmcnt(8)
  v_mfma_f32_16x16x32_bf16 v[180:183], v[84:87], v[120:123], v[180:183]
  s_waitcnt vmcnt(7)
  v_mfma_f32_16x16x32_bf16 v[176:179], v[88:91], v[124:127], v[176:179]
  s_waitcnt vmcnt(6)
  v_mfma_f32_16x16x32_bf16 v[180:183], v[92:95], v[124:127], v[180:183]
  s_waitcnt vmcnt(5)
  v_mfma_f32_16x16x32_bf16 v[176:179], v[96:99], v[128:131], v[176:179]
  s_waitcnt vmcnt(4)
  v_mfma_f32_16x16x32_bf16 v[180:183], v[100:103], v[128:131], v[180:183]
  s_waitcnt vmcnt(3)
  v_mfma_f32_16x16x32_bf16 v[176:179], v[104:107], v[132:135], v[176:179]
  s_waitcnt vmcnt(2)
  v_mfma_f32_16x16x32_bf16 v[180:183], v[108:111], v[132:135], v[180:183]
  v_mfma_f32_16x16x32_bf16 v[184:187], v[64:67], v[136:139], 0
  v_mfma_f32_16x16x32_bf16 v[188:191], v[68:71], v[136:139], 0
  v_mfma_f32_16x16x32_bf16 v[184:187], v[72:75], v[140:143], v[184:187]
  v_mfma_f32_16x16x32_bf16 v[188:191], v[76:79], v[140:143], v[188:191]
  v_mfma_f32_16x16x32_bf16 v[184:187], v[80:83], v[144:147], v[184:187]
  v_mfma_f32_16x16x32_bf16 v[188:191], v[84:87], v[144:147], v[188:191]
  v_mfma_f32_16x16x32_bf16 v[184:187], v[88:91], v[148:151], v[184:187]
  v_mfma_f32_16x16x32_bf16 v[188:191], v[92:95], v[148:151], v[188:191]
  v_mfma_f32_16x16x32_bf16 v[184:187], v[96:99], v[152:155], v[184:187]
  v_mfma_f32_16x16x32_bf16 v[188:191], v[100:103], v[152:155], v[188:191]
  v_mfma_f32_16x16x32_bf16 v[184:187], v[104:107], v[156:159], v[184:187]
  v_mfma_f32_16x16x32_bf16 v[188:191], v[108:111], v[156:159], v[188:191]
  v_cvt_pk_bf16_f32 v176, v176, v177
  v_cvt_pk_bf16_f32 v177, v178, v179
  v_cvt_pk_bf16_f32 v178, v180, v181
  v_cvt_pk_bf16_f32 v179, v182, v183
  s_and_b32 s26, s24, 1
  s_add_u32 s26, s26, 4
  s_lshl_b32 s26, s26, 10
  s_cmp_ge_u32 s24, 2
  s_cselect_b32 s27, 0x7f000000, 0
  s_add_u32 s26, s26, s27
  s_add_u32 s26, s26, s32
  s_add_u32 s26, s26, 0
  buffer_store_dwordx4 v[176:179], v13, s[20:23], s26 offen sc1
  v_cvt_pk_bf16_f32 v184, v184, v185
  v_cvt_pk_bf16_f32 v185, v186, v187
  v_cvt_pk_bf16_f32 v186, v188, v189
  v_cvt_pk_bf16_f32 v187, v190, v191
  s_and_b32 s26, s24, 1
  s_add_u32 s26, s26, 4
  s_lshl_b32 s26, s26, 10
  s_cmp_ge_u32 s24, 2
  s_cselect_b32 s27, 0x7f000000, 0
  s_add_u32 s26, s26, s27
  s_add_u32 s26, s26, s32
  s_add_u32 s26, s26, 6144
  buffer_store_dwordx4 v[184:187], v13, s[20:23], s26 offen sc1
  s_endpgm
LA_end:
  s_endpgm
.globl standalone__video_timesformer__vision_b_kernel
.p2align 8
.type standalone__video_timesformer__vision_b_kernel,@function
standalone__video_timesformer__vision_b_kernel:
  s_cmp_ge_u32 s2, 216
  s_cbranch_scc1 LB_end
  s_load_dwordx2 s[20:21], s[0:1], 56
  s_load_dwordx2 s[16:17], s[0:1], 40
  v_lshrrev_b32 v4, 6, v0
  v_and_b32 v1, 63, v0
  v_readfirstlane_b32 s24, v4
  s_mov_b32 s22, 16777216
  s_mov_b32 s23, 0x00020000
  v_lshlrev_b32 v16, 4, v1
  s_and_b32 s25, s2, 7
  s_lshr_b32 s26, s2, 3
  s_mul_i32 s32, s25, 503808
  s_mul_i32 s30, s24, 36864
  s_mov_b32 s27, s24
  s_mul_i32 s28, s26, 6
  s_add_u32 s28, s28, s27
  s_lshr_b32 s29, s28, 2
  s_mul_i32 s29, s29, 12288
  s_and_b32 s28, s28, 3
  s_lshl_b32 s28, s28, 10
  s_add_u32 s29, s29, s28
  s_add_u32 s36, s29, s32
  s_and_b32 s28, s27, 1
  s_lshl_b32 s28, s28, 10
  s_lshr_b32 s29, s27, 1
  s_mul_i32 s29, s29, 6144
  s_add_u32 s28, s28, s29
  s_add_u32 s37, s28, 12288
  s_and_b32 s27, s24, 1
  s_add_u32 s27, s27, 4
  s_mul_i32 s28, s26, 6
  s_add_u32 s28, s28, s27
  s_lshr_b32 s29, s28, 2
  s_mul_i32 s29, s29, 12288
  s_and_b32 s28, s28, 3
  s_lshl_b32 s28, s28, 10
  s_add_u32 s29, s29, s28
  s_add_u32 s38, s29, s32
  s_and_b32 s28, s27, 1
  s_lshl_b32 s28, s28, 10
  s_add_u32 s39, s28, 24576
  s_mul_i32 s27, s24, 6144
  s_add_u32 s40, s27, 8388608
  s_add_u32 s41, s40, 24576
  s_add_u32 s42, s40, 49152
  v_add_u32 v17, 4096, v16
  v_add_u32 v18, 8192, v16
  s_add_u32 m0, s37, 0
  s_waitcnt lgkmcnt(0)
  buffer_load_dwordx4 v16, s[20:23], s36 offen lds
  s_add_u32 m0, s37, 2048
  s_nop 0
  buffer_load_dwordx4 v17, s[20:23], s36 offen lds
  s_add_u32 m0, s37, 4096
  s_nop 0
  buffer_load_dwordx4 v18, s[20:23], s36 offen lds
  s_add_u32 m0, s39, 0
  s_nop 0
  buffer_load_dwordx4 v16, s[20:23], s38 offen lds
  s_add_u32 m0, s39, 2048
  s_nop 0
  buffer_load_dwordx4 v17, s[20:23], s38 offen lds
  s_add_u32 m0, s39, 4096
  s_nop 0
  buffer_load_dwordx4 v18, s[20:23], s38 offen lds
  s_mul_i32 s27, s26, 22
  v_add_u32 v4, s27, v1
  v_cmp_gt_u32 vcc, 22, v1
  v_lshlrev_b32 v4, 7, v4
  s_cmp_lt_u32 s24, 2
  s_mov_b32 s27, 9043968
  s_cselect_b32 s27, 8388608, s27
  v_mov_b32 v5, 0x7fffffff
  v_cndmask_b32 v4, v5, v4, vcc
  buffer_load_dword v111, v4, s[20:23], s27 offen
  s_lshr_b32 s36, s24, 1
  s_lshl_b32 s37, s36, 12
  s_lshl_b32 s36, s36, 11
  s_and_b32 s38, s24, 1
  s_lshl_b32 s38, s38, 10
  s_add_u32 s37, s37, s38
  s_add_u32 s36, s36, s38
  s_add_u32 s39, s32, 491520
  s_add_u32 s37, s37, s39
  s_add_u32 m0, s36, 153600
  s_nop 0
  buffer_load_dwordx4 v16, s[20:23], s37 offen lds
  s_add_u32 s37, s39, s38
  s_add_u32 s37, s37, 8192
  s_add_u32 m0, s38, 157696
  s_nop 0
  buffer_load_dwordx4 v16, s[20:23], s37 offen lds
  v_lshrrev_b32 v2, 4, v1
  v_and_b32 v3, 15, v1
  v_lshrrev_b32 v4, 3, v3
  v_lshlrev_b32 v4, 10, v4
  v_and_b32 v5, 7, v3
  v_lshl_add_u32 v4, v5, 7, v4
  v_bfe_u32 v5, v3, 1, 2
  v_lshlrev_b32 v5, 1, v5
  v_xor_b32 v5, v5, v2
  v_lshl_add_u32 v8, v5, 4, v4
  v_xor_b32 v9, 64, v8
  s_mul_i32 s34, s24, 122880
  s_add_u32 s34, s34, s32
  s_add_u32 s33, s34, 122880
  s_mul_hi_u32 s27, s26, 429496730
  s_mul_i32 s27, s27, 10
  s_sub_u32 s27, s26, s27
  s_mul_i32 s27, s27, 12288
  s_add_u32 s31, s34, s27
  s_mov_b32 s43, s31
  s_mov_b32 s18, 3981312
  s_mov_b32 s19, 0x00020000
  s_mov_b32 s35, 0
  v_add_u32 v10, s30, v8
  v_add_u32 v11, s30, v9
  v_lshrrev_b32 v4, 1, v2
  v_lshlrev_b32 v4, 10, v4
  v_and_b32 v5, 1, v2
  v_lshlrev_b32 v5, 2, v5
  v_lshrrev_b32 v6, 2, v3
  v_add_u32 v5, v5, v6
  v_lshl_add_u32 v4, v5, 7, v4
  v_bfe_u32 v5, v5, 1, 2
  v_lshlrev_b32 v5, 1, v5
  v_bfe_u32 v6, v3, 1, 1
  v_xor_b32 v5, v5, v6
  v_and_b32 v6, 1, v3
  v_lshl_add_u32 v4, v6, 3, v4
  v_add_u32 v4, s30, v4
  s_xor_b32 s27, s24, 0
  s_lshl_b32 s27, s27, 1
  v_xor_b32 v6, s27, v5
  v_lshl_add_u32 v12, v6, 4, v4
  s_xor_b32 s27, s24, 1
  s_lshl_b32 s27, s27, 1
  v_xor_b32 v6, s27, v5
  v_lshl_add_u32 v13, v6, 4, v4
  s_xor_b32 s27, s24, 2
  s_lshl_b32 s27, s27, 1
  v_xor_b32 v6, s27, v5
  v_lshl_add_u32 v14, v6, 4, v4
  s_xor_b32 s27, s24, 3
  s_lshl_b32 s27, s27, 1
  v_xor_b32 v6, s27, v5
  v_lshl_add_u32 v15, v6, 4, v4
  v_mov_b32 v4, 0x3f803f80
  v_mov_b32 v5, 0x3e803e80
  v_accvgpr_write_b32 a116, v4
  v_accvgpr_write_b32 a117, v4
  v_accvgpr_write_b32 a118, v4
  v_accvgpr_write_b32 a119, v4
  v_accvgpr_write_b32 a120, v5
  v_accvgpr_write_b32 a121, v5
  v_lshrrev_b32 v4, 2, v3
  v_cmp_eq_u32 vcc, v4, v2
  v_and_b32 v5, 3, v3
  v_mov_b32 v6, 0x3f80
  v_cndmask_b32 v6, 0, v6, vcc
  v_and_b32 v4, 1, v5
  v_lshlrev_b32 v4, 4, v4
  v_lshlrev_b32 v6, v4, v6
  v_cmp_gt_u32 vcc, 2, v5
  s_lshr_b32 s27, s24, 1
  s_lshl_b32 s27, s27, 10
  v_cndmask_b32 v4, 0, v6, vcc
  v_cndmask_b32 v5, v6, 0, vcc
  v_accvgpr_write_b32 a122, v4
  v_accvgpr_write_b32 a123, v5
  v_accvgpr_write_b32 a124, v4
  v_accvgpr_write_b32 a125, v5
  s_and_b32 s28, s24, 1
  s_lshl_b32 s28, s28, 3
  s_add_u32 s27, s27, s28
  s_add_u32 s28, s27, 135168
  v_add_u32 v4, s28, v16
  v_add_u32 v27, s27, v16
  v_add_u32 v5, 135168, v16
  s_mul_i32 s29, s26, 48
  v_add_u32 v28, s29, v3
  s_mul_i32 s28, s25, 1296
  v_add_u32 v29, s28, v28
  v_lshlrev_b32 v30, 3, v29
  v_accvgpr_write_b32 a102, v30
  v_mul_u32_u24 v26, 384, v29
  s_mul_i32 s29, s24, 96
  v_lshlrev_b32 v30, 4, v2
  v_add3_u32 v26, v26, v30, s29
  v_lshlrev_b32 v30, 3, v2
  v_sub_u32 v19, v26, v30
  s_mul_i32 s29, s24, 6
  v_add_u32 v31, s29, v2
  v_lshrrev_b32 v32, 1, v2
  v_add3_u32 v32, v32, s29, 4
  v_lshrrev_b32 v33, 3, v31
  v_lshlrev_b32 v33, 12, v33
  v_lshrrev_b32 v34, 3, v32
  v_lshlrev_b32 v34, 12, v34
  v_and_b32 v35, 1, v2
  v_lshl_add_u32 v34, v35, 3, v34
  v_and_b32 v31, 7, v31
  v_and_b32 v32, 7, v32
  v_bfe_u32 v35, v28, 1, 2
  v_lshlrev_b32 v35, 1, v35
  v_xor_b32 v31, v31, v35
  v_xor_b32 v32, v32, v35
  v_lshl_add_u32 v33, v31, 4, v33
  v_lshl_add_u32 v34, v32, 4, v34
  v_add_u32 v36, 0, v28
  v_lshrrev_b32 v37, 5, v36
  v_mul_u32_u24 v37, 12288, v37
  v_and_b32 v36, 31, v36
  v_lshl_add_u32 v37, v36, 7, v37
  v_add_u32 v36, v37, v33
  v_add_u32 v37, v37, v34
  v_accvgpr_write_b32 a96, v36
  v_accvgpr_write_b32 a97, v37
  v_add_u32 v36, 16, v28
  v_lshrrev_b32 v37, 5, v36
  v_mul_u32_u24 v37, 12288, v37
  v_and_b32 v36, 31, v36
  v_lshl_add_u32 v37, v36, 7, v37
  v_add_u32 v36, v37, v33
  v_add_u32 v37, v37, v34
  v_accvgpr_write_b32 a98, v36
  v_accvgpr_write_b32 a99, v37
  v_add_u32 v36, 32, v28
  v_lshrrev_b32 v37, 5, v36
  v_mul_u32_u24 v37, 12288, v37
  v_and_b32 v36, 31, v36
  v_lshl_add_u32 v37, v36, 7, v37
  v_add_u32 v36, v37, v33
  v_add_u32 v37, v37, v34
  v_accvgpr_write_b32 a100, v36
  v_accvgpr_write_b32 a101, v37
  buffer_load_dwordx4 a[128:131], v16, s[20:23], s40 offen offset:0
  buffer_load_dwordx4 a[152:155], v16, s[20:23], s41 offen offset:0
  buffer_load_dwordx4 a[176:179], v16, s[20:23], s42 offen offset:0
  buffer_load_dwordx4 a[132:135], v16, s[20:23], s40 offen offset:1024
  s_waitcnt vmcnt(7)
  s_barrier
  ds_read_b128 v[112:115], v8 offset:12288
  ds_read_b128 v[136:139], v8 offset:18432
  ds_read_b128 v[160:163], v8 offset:24576
  ds_read_b128 v[116:119], v9 offset:12288
  ds_read_b128 v[140:143], v9 offset:18432
  ds_read_b128 v[164:167], v9 offset:24576
  ds_read_b128 v[120:123], v8 offset:14336
  ds_read_b128 v[144:147], v8 offset:20480
  ds_read_b128 v[168:171], v8 offset:26624
  ds_read_b128 v[124:127], v9 offset:14336
  ds_read_b128 v[148:151], v9 offset:20480
  ds_read_b128 v[172:175], v9 offset:26624
  ds_read_b128 v[128:131], v8 offset:16384
  ds_read_b128 v[152:155], v8 offset:22528
  ds_read_b128 v[176:179], v8 offset:28672
  ds_read_b128 v[132:135], v9 offset:16384
  ds_read_b128 v[156:159], v9 offset:22528
  ds_read_b128 v[180:183], v9 offset:28672
  buffer_load_dwordx4 a[156:159], v16, s[20:23], s41 offen offset:1024
  buffer_load_dwordx4 a[180:183], v16, s[20:23], s42 offen offset:1024
  s_waitcnt vmcnt(5) lgkmcnt(14)
  v_mfma_f32_16x16x32_bf16 v[64:67], a[128:131], v[112:115], 0
  buffer_load_dwordx4 a[136:139], v16, s[20:23], s40 offen offset:2048
  v_mfma_f32_16x16x32_bf16 v[68:71], a[128:131], v[136:139], 0
  v_mfma_f32_16x16x32_bf16 v[72:75], a[128:131], v[160:163], 0
  s_waitcnt vmcnt(5)
  v_mfma_f32_16x16x32_bf16 v[76:79], a[152:155], v[112:115], 0
  buffer_load_dwordx4 a[160:163], v16, s[20:23], s41 offen offset:2048
  v_mfma_f32_16x16x32_bf16 v[80:83], a[152:155], v[136:139], 0
  v_mfma_f32_16x16x32_bf16 v[84:87], a[152:155], v[160:163], 0
  s_waitcnt vmcnt(5)
  v_mfma_f32_16x16x32_bf16 v[88:91], a[176:179], v[112:115], 0
  buffer_load_dwordx4 a[184:187], v16, s[20:23], s42 offen offset:2048
  v_mfma_f32_16x16x32_bf16 v[92:95], a[176:179], v[136:139], 0
  v_mfma_f32_16x16x32_bf16 v[96:99], a[176:179], v[160:163], 0
  s_waitcnt vmcnt(5)
  v_mfma_f32_16x16x32_bf16 v[64:67], a[132:135], v[116:119], v[64:67]
  buffer_load_dwordx4 a[140:143], v16, s[20:23], s40 offen offset:3072
  s_waitcnt lgkmcnt(13)
  v_mfma_f32_16x16x32_bf16 v[68:71], a[132:135], v[140:143], v[68:71]
  s_waitcnt lgkmcnt(12)
  v_mfma_f32_16x16x32_bf16 v[72:75], a[132:135], v[164:167], v[72:75]
  s_waitcnt vmcnt(5)
  v_mfma_f32_16x16x32_bf16 v[76:79], a[156:159], v[116:119], v[76:79]
  buffer_load_dwordx4 a[164:167], v16, s[20:23], s41 offen offset:3072
  v_mfma_f32_16x16x32_bf16 v[80:83], a[156:159], v[140:143], v[80:83]
  v_mfma_f32_16x16x32_bf16 v[84:87], a[156:159], v[164:167], v[84:87]
  s_waitcnt vmcnt(5)
  v_mfma_f32_16x16x32_bf16 v[88:91], a[180:183], v[116:119], v[88:91]
  buffer_load_dwordx4 a[188:191], v16, s[20:23], s42 offen offset:3072
  v_mfma_f32_16x16x32_bf16 v[92:95], a[180:183], v[140:143], v[92:95]
  v_mfma_f32_16x16x32_bf16 v[96:99], a[180:183], v[164:167], v[96:99]
  s_waitcnt vmcnt(5) lgkmcnt(11)
  v_mfma_f32_16x16x32_bf16 v[64:67], a[136:139], v[120:123], v[64:67]
  buffer_load_dwordx4 a[144:147], v17, s[20:23], s40 offen offset:0
  s_waitcnt lgkmcnt(10)
  v_mfma_f32_16x16x32_bf16 v[68:71], a[136:139], v[144:147], v[68:71]
  s_waitcnt lgkmcnt(9)
  v_mfma_f32_16x16x32_bf16 v[72:75], a[136:139], v[168:171], v[72:75]
  s_waitcnt vmcnt(5)
  v_mfma_f32_16x16x32_bf16 v[76:79], a[160:163], v[120:123], v[76:79]
  buffer_load_dwordx4 a[168:171], v17, s[20:23], s41 offen offset:0
  v_mfma_f32_16x16x32_bf16 v[80:83], a[160:163], v[144:147], v[80:83]
  v_mfma_f32_16x16x32_bf16 v[84:87], a[160:163], v[168:171], v[84:87]
  s_waitcnt vmcnt(5)
  v_mfma_f32_16x16x32_bf16 v[88:91], a[184:187], v[120:123], v[88:91]
  buffer_load_dwordx4 a[192:195], v17, s[20:23], s42 offen offset:0
  v_mfma_f32_16x16x32_bf16 v[92:95], a[184:187], v[144:147], v[92:95]
  v_mfma_f32_16x16x32_bf16 v[96:99], a[184:187], v[168:171], v[96:99]
  s_waitcnt vmcnt(5) lgkmcnt(8)
  v_mfma_f32_16x16x32_bf16 v[64:67], a[140:143], v[124:127], v[64:67]
  buffer_load_dwordx4 a[148:151], v17, s[20:23], s40 offen offset:1024
  s_waitcnt lgkmcnt(7)
  v_mfma_f32_16x16x32_bf16 v[68:71], a[140:143], v[148:151], v[68:71]
  s_waitcnt lgkmcnt(6)
  v_mfma_f32_16x16x32_bf16 v[72:75], a[140:143], v[172:175], v[72:75]
  s_waitcnt vmcnt(5)
  v_mfma_f32_16x16x32_bf16 v[76:79], a[164:167], v[124:127], v[76:79]
  buffer_load_dwordx4 a[172:175], v17, s[20:23], s41 offen offset:1024
  v_mfma_f32_16x16x32_bf16 v[80:83], a[164:167], v[148:151], v[80:83]
  v_mfma_f32_16x16x32_bf16 v[84:87], a[164:167], v[172:175], v[84:87]
  s_waitcnt vmcnt(5)
  v_mfma_f32_16x16x32_bf16 v[88:91], a[188:191], v[124:127], v[88:91]
  buffer_load_dwordx4 a[196:199], v17, s[20:23], s42 offen offset:1024
  v_mfma_f32_16x16x32_bf16 v[92:95], a[188:191], v[148:151], v[92:95]
  v_mfma_f32_16x16x32_bf16 v[96:99], a[188:191], v[172:175], v[96:99]
  s_waitcnt vmcnt(5) lgkmcnt(5)
  v_mfma_f32_16x16x32_bf16 v[64:67], a[144:147], v[128:131], v[64:67]
  s_waitcnt lgkmcnt(4)
  v_mfma_f32_16x16x32_bf16 v[68:71], a[144:147], v[152:155], v[68:71]
  s_waitcnt lgkmcnt(3)
  v_mfma_f32_16x16x32_bf16 v[72:75], a[144:147], v[176:179], v[72:75]
  s_waitcnt vmcnt(4)
  v_mfma_f32_16x16x32_bf16 v[76:79], a[168:171], v[128:131], v[76:79]
  v_mfma_f32_16x16x32_bf16 v[80:83], a[168:171], v[152:155], v[80:83]
  v_mfma_f32_16x16x32_bf16 v[84:87], a[168:171], v[176:179], v[84:87]
  s_waitcnt vmcnt(3)
  v_mfma_f32_16x16x32_bf16 v[88:91], a[192:195], v[128:131], v[88:91]
  v_mfma_f32_16x16x32_bf16 v[92:95], a[192:195], v[152:155], v[92:95]
  v_mfma_f32_16x16x32_bf16 v[96:99], a[192:195], v[176:179], v[96:99]
  s_waitcnt vmcnt(2) lgkmcnt(2)
  v_mfma_f32_16x16x32_bf16 v[64:67], a[148:151], v[132:135], v[64:67]
  s_waitcnt lgkmcnt(1)
  v_mfma_f32_16x16x32_bf16 v[68:71], a[148:151], v[156:159], v[68:71]
  s_waitcnt lgkmcnt(0)
  v_mfma_f32_16x16x32_bf16 v[72:75], a[148:151], v[180:183], v[72:75]
  s_waitcnt vmcnt(1)
  v_mfma_f32_16x16x32_bf16 v[76:79], a[172:175], v[132:135], v[76:79]
  v_mfma_f32_16x16x32_bf16 v[80:83], a[172:175], v[156:159], v[80:83]
  v_mfma_f32_16x16x32_bf16 v[84:87], a[172:175], v[180:183], v[84:87]
  s_waitcnt vmcnt(0)
  v_mfma_f32_16x16x32_bf16 v[88:91], a[196:199], v[132:135], v[88:91]
  v_mfma_f32_16x16x32_bf16 v[92:95], a[196:199], v[156:159], v[92:95]
  v_mfma_f32_16x16x32_bf16 v[96:99], a[196:199], v[180:183], v[96:99]
  v_cvt_pk_bf16_f32 v64, v64, v65
  v_cvt_pk_bf16_f32 v65, v66, v67
  ds_write_b64 v4, v[64:65] offset:0
  v_cvt_pk_bf16_f32 v68, v68, v69
  v_cvt_pk_bf16_f32 v69, v70, v71
  ds_write_b64 v4, v[68:69] offset:6144
  v_cvt_pk_bf16_f32 v72, v72, v73
  v_cvt_pk_bf16_f32 v73, v74, v75
  ds_write_b64 v4, v[72:73] offset:12288
  v_cvt_pk_bf16_f32 v76, v76, v77
  v_cvt_pk_bf16_f32 v77, v78, v79
  ds_write_b64 v4, v[76:77] offset:2048
  v_cvt_pk_bf16_f32 v80, v80, v81
  v_cvt_pk_bf16_f32 v81, v82, v83
  ds_write_b64 v4, v[80:81] offset:8192
  v_cvt_pk_bf16_f32 v84, v84, v85
  v_cvt_pk_bf16_f32 v85, v86, v87
  ds_write_b64 v4, v[84:85] offset:14336
  v_cvt_pk_bf16_f32 v88, v88, v89
  v_cvt_pk_bf16_f32 v89, v90, v91
  ds_write_b64 v4, v[88:89] offset:4096
  v_cvt_pk_bf16_f32 v92, v92, v93
  v_cvt_pk_bf16_f32 v93, v94, v95
  ds_write_b64 v4, v[92:93] offset:10240
  v_cvt_pk_bf16_f32 v96, v96, v97
  v_cvt_pk_bf16_f32 v97, v98, v99
  ds_write_b64 v4, v[96:97] offset:16384
  s_waitcnt lgkmcnt(0)
  s_barrier
  v_add_u32 v8, 153600, v8
  v_add_u32 v9, 153600, v9
  ds_read_b128 a[0:3], v5 offset:0
  ds_read_b128 a[24:27], v5 offset:6144
  ds_read_b128 a[48:51], v5 offset:12288
  ds_read_b128 v[112:115], v8 offset:0
  s_add_u32 m0, s30, 0
  s_nop 0
  buffer_load_dwordx4 v16, s[20:23], s31 offen offset:0 lds
  ds_read_b128 a[4:7], v5 offset:1024
  ds_read_b128 a[28:31], v5 offset:7168
  ds_read_b128 a[52:55], v5 offset:13312
  ds_read_b128 v[116:119], v9 offset:0
  buffer_load_dwordx4 v16, s[20:23], s31 offen offset:1024 lds
  ds_read_b128 a[8:11], v5 offset:2048
  ds_read_b128 a[32:35], v5 offset:8192
  ds_read_b128 a[56:59], v5 offset:14336
  ds_read_b128 v[120:123], v8 offset:2048
  buffer_load_dwordx4 v16, s[20:23], s31 offen offset:2048 lds
  ds_read_b128 a[12:15], v5 offset:3072
  ds_read_b128 a[36:39], v5 offset:9216
  ds_read_b128 a[60:63], v5 offset:15360
  ds_read_b128 v[124:127], v9 offset:2048
  ds_read_b128 a[16:19], v5 offset:4096
  ds_read_b128 a[40:43], v5 offset:10240
  ds_read_b128 a[64:67], v5 offset:16384
  ds_read_b128 v[128:131], v8 offset:4096
  ds_read_b128 a[20:23], v5 offset:5120
  ds_read_b128 a[44:47], v5 offset:11264
  ds_read_b128 a[68:71], v5 offset:17408
  ds_read_b128 v[132:135], v9 offset:4096
  s_waitcnt lgkmcnt(14)
  v_mfma_f32_16x16x32_bf16 v[88:91], v[112:115], a[0:3], 0
  v_mfma_f32_16x16x32_bf16 v[92:95], v[112:115], a[24:27], 0
  v_mfma_f32_16x16x32_bf16 v[96:99], v[112:115], a[48:51], 0
  buffer_load_dwordx4 v16, s[20:23], s31 offen offset:3072 lds
  v_mfma_f32_16x16x32_bf16 v[88:91], v[116:119], a[4:7], v[88:91]
  v_mfma_f32_16x16x32_bf16 v[92:95], v[116:119], a[28:31], v[92:95]
  v_mfma_f32_16x16x32_bf16 v[96:99], v[116:119], a[52:55], v[96:99]
  s_add_u32 m0, s30, 4096
  s_nop 0
  buffer_load_dwordx4 v17, s[20:23], s31 offen offset:0 lds
  s_waitcnt lgkmcnt(12)
  v_mfma_f32_16x16x32_bf16 v[88:91], v[120:123], a[8:11], v[88:91]
  v_mfma_f32_16x16x32_bf16 v[92:95], v[120:123], a[32:35], v[92:95]
  v_mfma_f32_16x16x32_bf16 v[96:99], v[120:123], a[56:59], v[96:99]
  buffer_load_dwordx4 v17, s[20:23], s31 offen offset:1024 lds
  s_waitcnt lgkmcnt(8)
  v_mfma_f32_16x16x32_bf16 v[88:91], v[124:127], a[12:15], v[88:91]
  v_mfma_f32_16x16x32_bf16 v[92:95], v[124:127], a[36:39], v[92:95]
  v_mfma_f32_16x16x32_bf16 v[96:99], v[124:127], a[60:63], v[96:99]
  buffer_load_dwordx4 v17, s[20:23], s31 offen offset:2048 lds
  s_waitcnt lgkmcnt(4)
  v_mfma_f32_16x16x32_bf16 v[88:91], v[128:131], a[16:19], v[88:91]
  v_mfma_f32_16x16x32_bf16 v[92:95], v[128:131], a[40:43], v[92:95]
  v_mfma_f32_16x16x32_bf16 v[96:99], v[128:131], a[64:67], v[96:99]
  buffer_load_dwordx4 v17, s[20:23], s31 offen offset:3072 lds
  s_waitcnt lgkmcnt(0)
  v_mfma_f32_16x16x32_bf16 v[88:91], v[132:135], a[20:23], v[88:91]
  v_mfma_f32_16x16x32_bf16 v[92:95], v[132:135], a[44:47], v[92:95]
  v_mfma_f32_16x16x32_bf16 v[96:99], v[132:135], a[68:71], v[96:99]
  s_add_u32 m0, s30, 8192
  s_nop 0
  buffer_load_dwordx4 v18, s[20:23], s31 offen offset:0 lds
  s_barrier
  s_nop 1
  v_max3_f32 v4, v88, v89, v90
  v_max_f32 v4, v4, v91
  v_mov_b32 v7, v4
  v_max3_f32 v5, v92, v93, v94
  v_max_f32 v5, v5, v95
  v_mov_b32 v8, v5
  v_max3_f32 v6, v96, v97, v98
  v_max_f32 v6, v6, v99
  v_mov_b32 v9, v6
  buffer_load_dwordx4 v18, s[20:23], s31 offen offset:1024 lds
  v_permlane16_swap_b32 v4, v7
  v_permlane16_swap_b32 v5, v8
  v_permlane16_swap_b32 v6, v9
  v_max_f32 v4, v4, v7
  v_mov_b32 v7, v4
  v_max_f32 v5, v5, v8
  v_mov_b32 v8, v5
  v_max_f32 v6, v6, v9
  v_mov_b32 v9, v6
  buffer_load_dwordx4 v18, s[20:23], s31 offen offset:2048 lds
  v_permlane32_swap_b32 v4, v7
  v_permlane32_swap_b32 v5, v8
  v_permlane32_swap_b32 v6, v9
  v_max_f32 v4, v4, v7
  v_max_f32 v5, v5, v8
  v_max_f32 v6, v6, v9
  v_sub_f32 v28, 0, v4
  v_sub_f32 v29, 0, v4
  v_sub_f32 v30, 0, v4
  v_sub_f32 v31, 0, v4
  v_sub_f32 v32, 0, v5
  v_sub_f32 v33, 0, v5
  v_sub_f32 v34, 0, v5
  v_sub_f32 v35, 0, v5
  v_sub_f32 v36, 0, v6
  v_sub_f32 v37, 0, v6
  v_sub_f32 v38, 0, v6
  v_sub_f32 v39, 0, v6
LB_pre:
  s_waitcnt vmcnt(7)
  ds_read_b128 a[72:75], v10 offset:0
  ds_read_b128 a[76:79], v10 offset:2048
  ds_read_b128 a[80:83], v11 offset:0
  ds_read_b128 a[84:87], v11 offset:2048
  s_waitcnt lgkmcnt(3)
  v_mfma_f32_16x16x32_bf16 v[64:67], a[72:75], a[0:3], v[28:31]
  v_add_f32 v88, v88, v28
  v_add_f32 v89, v89, v28
  v_mfma_f32_16x16x32_bf16 v[68:71], a[72:75], a[24:27], v[32:35]
  buffer_load_dwordx4 v18, s[20:23], s31 offen offset:3072 lds
  v_mfma_f32_16x16x32_bf16 v[72:75], a[72:75], a[48:51], v[36:39]
  s_waitcnt vmcnt(4)
  ds_read_b128 a[88:91], v10 offset:4096
  s_waitcnt lgkmcnt(3)
  v_mfma_f32_16x16x32_bf16 v[76:79], a[76:79], a[0:3], v[28:31]
  v_exp_f32 v88, v88
  v_mfma_f32_16x16x32_bf16 v[80:83], a[76:79], a[24:27], v[32:35]
  s_add_u32 s31, s31, 12288
  s_cmp_eq_u32 s31, s33
  s_cselect_b32 s31, s34, s31
  s_add_u32 m0, s30, 12288
  s_nop 0
  buffer_load_dwordx4 v16, s[20:23], s31 offen offset:0 lds
  v_exp_f32 v89, v89
  v_add_f32 v90, v90, v28
  v_add_f32 v91, v91, v28
  v_mfma_f32_16x16x32_bf16 v[84:87], a[76:79], a[48:51], v[36:39]
  ds_read_b128 a[72:75], v10 offset:6144
  s_waitcnt lgkmcnt(3)
  v_mfma_f32_16x16x32_bf16 v[64:67], a[80:83], a[4:7], v[64:67]
  v_exp_f32 v90, v90
  v_mfma_f32_16x16x32_bf16 v[68:71], a[80:83], a[28:31], v[68:71]
  buffer_load_dwordx4 v16, s[20:23], s31 offen offset:1024 lds
  v_exp_f32 v91, v91
  v_add_f32 v92, v92, v32
  v_add_f32 v93, v93, v32
  v_subrev_u32 v9, s30, v12
  v_add_u32 v9, 153600, v9
  v_mfma_f32_16x16x32_bf16 v[72:75], a[80:83], a[52:55], v[72:75]
  ds_read_b128 a[76:79], v11 offset:4096
  s_waitcnt lgkmcnt(3)
  v_mfma_f32_16x16x32_bf16 v[76:79], a[84:87], a[4:7], v[76:79]
  v_exp_f32 v92, v92
  v_mfma_f32_16x16x32_bf16 v[80:83], a[84:87], a[28:31], v[80:83]
  buffer_load_dwordx4 v16, s[20:23], s31 offen offset:2048 lds
  v_exp_f32 v93, v93
  v_add_f32 v94, v94, v32
  v_add_f32 v95, v95, v32
  v_mfma_f32_16x16x32_bf16 v[84:87], a[84:87], a[52:55], v[84:87]
  ds_read_b128 a[80:83], v11 offset:6144
  s_waitcnt lgkmcnt(3)
  v_mfma_f32_16x16x32_bf16 v[64:67], a[88:91], a[8:11], v[64:67]
  v_exp_f32 v94, v94
  v_mfma_f32_16x16x32_bf16 v[68:71], a[88:91], a[32:35], v[68:71]
  buffer_load_dwordx4 v16, s[20:23], s31 offen offset:3072 lds
  v_add_f32 v96, v96, v36
  v_add_f32 v97, v97, v36
  v_cvt_pk_bf16_f32 v20, v88, v89
  v_cvt_pk_bf16_f32 v21, v90, v91
  v_mfma_f32_16x16x32_bf16 v[72:75], a[88:91], a[56:59], v[72:75]
  s_waitcnt vmcnt(4)
  ds_read_b128 a[84:87], v10 offset:8192
  s_waitcnt lgkmcnt(3)
  v_mfma_f32_16x16x32_bf16 v[76:79], a[72:75], a[8:11], v[76:79]
  v_exp_f32 v95, v95
  v_mfma_f32_16x16x32_bf16 v[80:83], a[72:75], a[32:35], v[80:83]
  s_add_u32 m0, s30, 16384
  s_nop 0
  buffer_load_dwordx4 v17, s[20:23], s31 offen offset:0 lds
  v_exp_f32 v96, v96
  v_add_f32 v98, v98, v36
  v_add_f32 v99, v99, v36
  v_mfma_f32_16x16x32_bf16 v[84:87], a[72:75], a[56:59], v[84:87]
  ds_read_b128 a[88:91], v10 offset:10240
  s_waitcnt lgkmcnt(3)
  v_mfma_f32_16x16x32_bf16 v[64:67], a[76:79], a[12:15], v[64:67]
  v_exp_f32 v97, v97
  v_mfma_f32_16x16x32_bf16 v[68:71], a[76:79], a[36:39], v[68:71]
  buffer_load_dwordx4 v17, s[20:23], s31 offen offset:1024 lds
  v_exp_f32 v98, v98
  v_cvt_pk_bf16_f32 v22, v92, v93
  v_cvt_pk_bf16_f32 v23, v94, v95
  v_mfma_f32_16x16x32_bf16 v[72:75], a[76:79], a[60:63], v[72:75]
  ds_read_b128 a[72:75], v11 offset:8192
  s_waitcnt lgkmcnt(3)
  v_mfma_f32_16x16x32_bf16 v[76:79], a[80:83], a[12:15], v[76:79]
  v_exp_f32 v99, v99
  v_mfma_f32_16x16x32_bf16 v[80:83], a[80:83], a[36:39], v[80:83]
  buffer_load_dwordx4 v17, s[20:23], s31 offen offset:2048 lds
  v_mfma_f32_16x16x32_bf16 v[84:87], a[80:83], a[60:63], v[84:87]
  ds_read_b128 a[76:79], v11 offset:10240
  s_waitcnt lgkmcnt(3)
  v_mfma_f32_16x16x32_bf16 v[64:67], a[84:87], a[16:19], v[64:67]
  v_mfma_f32_16x16x32_bf16 v[68:71], a[84:87], a[40:43], v[68:71]
  buffer_load_dwordx4 v17, s[20:23], s31 offen offset:3072 lds
  v_mfma_f32_16x16x32_bf16 v[72:75], a[84:87], a[64:67], v[72:75]
  ds_read_b64_tr_b16 a[80:81], v9 offset:0
  s_waitcnt lgkmcnt(3)
  v_mfma_f32_16x16x32_bf16 v[76:79], a[88:91], a[16:19], v[76:79]
  v_cvt_pk_bf16_f32 v24, v96, v97
  v_cvt_pk_bf16_f32 v25, v98, v99
  v_mfma_f32_16x16x32_bf16 v[80:83], a[88:91], a[40:43], v[80:83]
  s_add_u32 m0, s30, 20480
  s_nop 0
  buffer_load_dwordx4 v18, s[20:23], s31 offen offset:0 lds
  v_mfma_f32_16x16x32_bf16 v[84:87], a[88:91], a[64:67], v[84:87]
  ds_read_b64_tr_b16 a[84:85], v9 offset:2048
  s_waitcnt lgkmcnt(3)
  v_mfma_f32_16x16x32_bf16 v[64:67], a[72:75], a[20:23], v[64:67]
  v_mfma_f32_16x16x32_bf16 v[68:71], a[72:75], a[44:47], v[68:71]
  buffer_load_dwordx4 v18, s[20:23], s31 offen offset:1024 lds
  v_mfma_f32_16x16x32_bf16 v[72:75], a[72:75], a[68:71], v[72:75]
  ds_read_b64_tr_b16 a[88:89], v9 offset:4096
  s_waitcnt lgkmcnt(3)
  v_mfma_f32_16x16x32_bf16 v[76:79], a[76:79], a[20:23], v[76:79]
  v_mfma_f32_16x16x32_bf16 v[80:83], a[76:79], a[44:47], v[80:83]
  buffer_load_dwordx4 v18, s[20:23], s31 offen offset:2048 lds
  v_mfma_f32_16x16x32_bf16 v[84:87], a[76:79], a[68:71], v[84:87]
  s_waitcnt lgkmcnt(2)
  v_mfma_f32_16x16x16_bf16 v[112:115], a[80:81], v[20:21], 0
  v_exp_f32 v64, v64
  v_mfma_f32_16x16x16_bf16 v[116:119], a[80:81], v[22:23], 0
  buffer_load_dwordx4 v18, s[20:23], s31 offen offset:3072 lds
  v_exp_f32 v65, v65
  v_mfma_f32_16x16x16_bf16 v[120:123], a[80:81], v[24:25], 0
  s_waitcnt vmcnt(8)
  ds_read_b128 a[72:75], v10 offset:12288
  s_waitcnt lgkmcnt(2)
  v_mfma_f32_16x16x16_bf16 v[160:163], a[84:85], v[20:21], 0
  v_exp_f32 v66, v66
  v_mfma_f32_16x16x16_bf16 v[164:167], a[84:85], v[22:23], 0
  s_add_u32 s31, s31, 12288
  s_cmp_eq_u32 s31, s33
  s_cselect_b32 s31, s34, s31
  s_add_u32 m0, s30, 24576
  s_nop 0
  buffer_load_dwordx4 v16, s[20:23], s31 offen offset:0 lds
  v_exp_f32 v67, v67
  v_cvt_pk_bf16_f32 v40, v64, v65
  v_mfma_f32_16x16x16_bf16 v[168:171], a[84:85], v[24:25], 0
  ds_read_b128 a[76:79], v10 offset:14336
  s_waitcnt lgkmcnt(2)
  v_mfma_f32_16x16x16_bf16 v[208:211], a[88:89], v[20:21], 0
  v_exp_f32 v68, v68
  v_mfma_f32_16x16x16_bf16 v[212:215], a[88:89], v[22:23], 0
  buffer_load_dwordx4 v16, s[20:23], s31 offen offset:1024 lds
  v_exp_f32 v69, v69
  v_cvt_pk_bf16_f32 v41, v66, v67
  v_mfma_f32_16x16x16_bf16 v[216:219], a[88:89], v[24:25], 0
  ds_read_b128 a[80:83], v11 offset:12288
  v_mfma_f32_16x16x16_bf16 a[104:107], a[120:121], v[20:21], 0
  v_exp_f32 v70, v70
  v_mfma_f32_16x16x16_bf16 a[108:111], a[120:121], v[22:23], 0
  buffer_load_dwordx4 v16, s[20:23], s31 offen offset:2048 lds
  v_cvt_pk_bf16_f32 v44, v68, v69
  v_mfma_f32_16x16x16_bf16 a[112:115], a[120:121], v[24:25], 0
  ds_read_b128 a[84:87], v11 offset:14336
  s_waitcnt lgkmcnt(3)
  v_mfma_f32_16x16x32_bf16 v[88:91], a[72:75], a[0:3], v[28:31]
  v_exp_f32 v71, v71
  v_mfma_f32_16x16x32_bf16 v[92:95], a[72:75], a[24:27], v[32:35]
  buffer_load_dwordx4 v16, s[20:23], s31 offen offset:3072 lds
  v_exp_f32 v72, v72
  v_mfma_f32_16x16x32_bf16 v[96:99], a[72:75], a[48:51], v[36:39]
  s_waitcnt vmcnt(8)
  ds_read_b128 a[88:91], v10 offset:16384
  s_waitcnt lgkmcnt(3)
  v_mfma_f32_16x16x32_bf16 v[100:103], a[76:79], a[0:3], v[28:31]
  v_exp_f32 v73, v73
  v_mfma_f32_16x16x32_bf16 v[104:107], a[76:79], a[24:27], v[32:35]
  s_add_u32 m0, s30, 28672
  s_nop 0
  buffer_load_dwordx4 v17, s[20:23], s31 offen offset:0 lds
  v_exp_f32 v74, v74
  v_cvt_pk_bf16_f32 v45, v70, v71
  v_mfma_f32_16x16x32_bf16 v[108:111], a[76:79], a[48:51], v[36:39]
  ds_read_b128 a[72:75], v10 offset:18432
  s_waitcnt lgkmcnt(3)
  v_mfma_f32_16x16x32_bf16 v[88:91], a[80:83], a[4:7], v[88:91]
  v_exp_f32 v75, v75
  v_mfma_f32_16x16x32_bf16 v[92:95], a[80:83], a[28:31], v[92:95]
  buffer_load_dwordx4 v17, s[20:23], s31 offen offset:1024 lds
  v_cvt_pk_bf16_f32 v48, v72, v73
  v_mfma_f32_16x16x32_bf16 v[96:99], a[80:83], a[52:55], v[96:99]
  ds_read_b128 a[76:79], v11 offset:16384
  s_waitcnt lgkmcnt(3)
  v_mfma_f32_16x16x32_bf16 v[100:103], a[84:87], a[4:7], v[100:103]
  v_exp_f32 v76, v76
  v_mfma_f32_16x16x32_bf16 v[104:107], a[84:87], a[28:31], v[104:107]
  buffer_load_dwordx4 v17, s[20:23], s31 offen offset:2048 lds
  v_exp_f32 v77, v77
  v_cvt_pk_bf16_f32 v49, v74, v75
  v_mfma_f32_16x16x32_bf16 v[108:111], a[84:87], a[52:55], v[108:111]
  ds_read_b128 a[80:83], v11 offset:18432
  s_waitcnt lgkmcnt(3)
  v_mfma_f32_16x16x32_bf16 v[88:91], a[88:91], a[8:11], v[88:91]
  v_exp_f32 v78, v78
  v_mfma_f32_16x16x32_bf16 v[92:95], a[88:91], a[32:35], v[92:95]
  buffer_load_dwordx4 v17, s[20:23], s31 offen offset:3072 lds
  v_exp_f32 v79, v79
  v_cvt_pk_bf16_f32 v42, v76, v77
  v_mfma_f32_16x16x32_bf16 v[96:99], a[88:91], a[56:59], v[96:99]
  s_waitcnt vmcnt(8)
  ds_read_b128 a[84:87], v10 offset:20480
  s_waitcnt lgkmcnt(3)
  v_mfma_f32_16x16x32_bf16 v[100:103], a[72:75], a[8:11], v[100:103]
  v_exp_f32 v80, v80
  v_mfma_f32_16x16x32_bf16 v[104:107], a[72:75], a[32:35], v[104:107]
  s_add_u32 m0, s30, 32768
  s_nop 0
  buffer_load_dwordx4 v18, s[20:23], s31 offen offset:0 lds
  v_exp_f32 v81, v81
  v_cvt_pk_bf16_f32 v43, v78, v79
  v_mfma_f32_16x16x32_bf16 v[108:111], a[72:75], a[56:59], v[108:111]
  ds_read_b128 a[88:91], v10 offset:22528
  s_waitcnt lgkmcnt(3)
  v_mfma_f32_16x16x32_bf16 v[88:91], a[76:79], a[12:15], v[88:91]
  v_exp_f32 v82, v82
  v_mfma_f32_16x16x32_bf16 v[92:95], a[76:79], a[36:39], v[92:95]
  buffer_load_dwordx4 v18, s[20:23], s31 offen offset:1024 lds
  v_cvt_pk_bf16_f32 v46, v80, v81
  v_mfma_f32_16x16x32_bf16 v[96:99], a[76:79], a[60:63], v[96:99]
  ds_read_b128 a[72:75], v11 offset:20480
  s_waitcnt lgkmcnt(3)
  v_mfma_f32_16x16x32_bf16 v[100:103], a[80:83], a[12:15], v[100:103]
  v_exp_f32 v83, v83
  v_mfma_f32_16x16x32_bf16 v[104:107], a[80:83], a[36:39], v[104:107]
  buffer_load_dwordx4 v18, s[20:23], s31 offen offset:2048 lds
  v_exp_f32 v84, v84
  v_mfma_f32_16x16x32_bf16 v[108:111], a[80:83], a[60:63], v[108:111]
  ds_read_b128 a[76:79], v11 offset:22528
  s_waitcnt lgkmcnt(3)
  v_mfma_f32_16x16x32_bf16 v[88:91], a[84:87], a[16:19], v[88:91]
  v_exp_f32 v85, v85
  v_mfma_f32_16x16x32_bf16 v[92:95], a[84:87], a[40:43], v[92:95]
  buffer_load_dwordx4 v18, s[20:23], s31 offen offset:3072 lds
  v_exp_f32 v86, v86
  v_cvt_pk_bf16_f32 v47, v82, v83
  v_mfma_f32_16x16x32_bf16 v[96:99], a[84:87], a[64:67], v[96:99]
  ds_read_b64_tr_b16 a[80:81], v12 offset:0
  s_waitcnt lgkmcnt(3)
  v_mfma_f32_16x16x32_bf16 v[100:103], a[88:91], a[16:19], v[100:103]
  v_exp_f32 v87, v87
  v_mfma_f32_16x16x32_bf16 v[104:107], a[88:91], a[40:43], v[104:107]
  ds_read_b64_tr_b16 a[82:83], v12 offset:2048
  s_add_u32 s31, s31, 12288
  s_cmp_eq_u32 s31, s33
  s_cselect_b32 s31, s34, s31
  v_cvt_pk_bf16_f32 v50, v84, v85
  v_mfma_f32_16x16x32_bf16 v[108:111], a[88:91], a[64:67], v[108:111]
  ds_read_b64_tr_b16 a[84:85], v13 offset:0
  s_waitcnt lgkmcnt(4)
  v_mfma_f32_16x16x32_bf16 v[88:91], a[72:75], a[20:23], v[88:91]
  v_cvt_pk_bf16_f32 v51, v86, v87
  v_mfma_f32_16x16x32_bf16 v[92:95], a[72:75], a[44:47], v[92:95]
  ds_read_b64_tr_b16 a[86:87], v13 offset:2048
  v_mfma_f32_16x16x32_bf16 v[96:99], a[72:75], a[68:71], v[96:99]
  ds_read_b64_tr_b16 a[88:89], v14 offset:0
  s_waitcnt lgkmcnt(5)
  v_mfma_f32_16x16x32_bf16 v[100:103], a[76:79], a[20:23], v[100:103]
  v_mfma_f32_16x16x32_bf16 v[104:107], a[76:79], a[44:47], v[104:107]
  ds_read_b64_tr_b16 a[90:91], v14 offset:2048
  v_mfma_f32_16x16x32_bf16 v[108:111], a[76:79], a[68:71], v[108:111]
  ds_read_b64_tr_b16 a[72:73], v15 offset:0
  s_waitcnt lgkmcnt(5)
  v_mfma_f32_16x16x32_bf16 v[112:115], a[80:83], v[40:43], v[112:115]
  v_exp_f32 v88, v88
  v_mfma_f32_16x16x32_bf16 v[116:119], a[80:83], v[44:47], v[116:119]
  ds_read_b64_tr_b16 a[74:75], v15 offset:2048
  v_exp_f32 v89, v89
  v_mfma_f32_16x16x32_bf16 v[120:123], a[80:83], v[48:51], v[120:123]
  ds_read_b64_tr_b16 a[76:77], v12 offset:4096
  s_waitcnt lgkmcnt(5)
  v_mfma_f32_16x16x32_bf16 v[124:127], a[84:87], v[40:43], 0
  v_exp_f32 v90, v90
  v_mfma_f32_16x16x32_bf16 v[128:131], a[84:87], v[44:47], 0
  ds_read_b64_tr_b16 a[78:79], v12 offset:6144
  v_cvt_pk_bf16_f32 v52, v88, v89
  v_mfma_f32_16x16x32_bf16 v[132:135], a[84:87], v[48:51], 0
  ds_read_b64_tr_b16 a[80:81], v13 offset:4096
  s_waitcnt lgkmcnt(5)
  v_mfma_f32_16x16x32_bf16 v[136:139], a[88:91], v[40:43], 0
  v_exp_f32 v91, v91
  v_mfma_f32_16x16x32_bf16 v[140:143], a[88:91], v[44:47], 0
  ds_read_b64_tr_b16 a[82:83], v13 offset:6144
  v_mfma_f32_16x16x32_bf16 v[144:147], a[88:91], v[48:51], 0
  ds_read_b64_tr_b16 a[84:85], v14 offset:4096
  s_waitcnt lgkmcnt(5)
  v_mfma_f32_16x16x32_bf16 v[148:151], a[72:75], v[40:43], 0
  v_exp_f32 v92, v92
  v_mfma_f32_16x16x32_bf16 v[152:155], a[72:75], v[44:47], 0
  ds_read_b64_tr_b16 a[86:87], v14 offset:6144
  v_cvt_pk_bf16_f32 v53, v90, v91
  v_mfma_f32_16x16x32_bf16 v[156:159], a[72:75], v[48:51], 0
  ds_read_b64_tr_b16 a[88:89], v15 offset:4096
  s_waitcnt lgkmcnt(5)
  v_mfma_f32_16x16x32_bf16 v[160:163], a[76:79], v[40:43], v[160:163]
  v_exp_f32 v93, v93
  v_mfma_f32_16x16x32_bf16 v[164:167], a[76:79], v[44:47], v[164:167]
  ds_read_b64_tr_b16 a[90:91], v15 offset:6144
  s_add_u32 m0, s30, 0
  s_nop 0
  buffer_load_dwordx4 v16, s[20:23], s31 offen offset:0 lds
  v_mfma_f32_16x16x32_bf16 v[168:171], a[76:79], v[48:51], v[168:171]
  ds_read_b64_tr_b16 a[72:73], v12 offset:8192
  s_waitcnt lgkmcnt(5)
  v_mfma_f32_16x16x32_bf16 v[172:175], a[80:83], v[40:43], 0
  v_exp_f32 v94, v94
  v_mfma_f32_16x16x32_bf16 v[176:179], a[80:83], v[44:47], 0
  ds_read_b64_tr_b16 a[74:75], v12 offset:10240
  v_cvt_pk_bf16_f32 v56, v92, v93
  v_mfma_f32_16x16x32_bf16 v[180:183], a[80:83], v[48:51], 0
  ds_read_b64_tr_b16 a[76:77], v13 offset:8192
  s_waitcnt lgkmcnt(5)
  v_mfma_f32_16x16x32_bf16 v[184:187], a[84:87], v[40:43], 0
  v_exp_f32 v95, v95
  v_mfma_f32_16x16x32_bf16 v[188:191], a[84:87], v[44:47], 0
  ds_read_b64_tr_b16 a[78:79], v13 offset:10240
  buffer_load_dwordx4 v16, s[20:23], s31 offen offset:1024 lds
  v_mfma_f32_16x16x32_bf16 v[192:195], a[84:87], v[48:51], 0
  ds_read_b64_tr_b16 a[80:81], v14 offset:8192
  s_waitcnt lgkmcnt(5)
  v_mfma_f32_16x16x32_bf16 v[196:199], a[88:91], v[40:43], 0
  v_exp_f32 v96, v96
  v_mfma_f32_16x16x32_bf16 v[200:203], a[88:91], v[44:47], 0
  ds_read_b64_tr_b16 a[82:83], v14 offset:10240
  v_cvt_pk_bf16_f32 v57, v94, v95
  v_mfma_f32_16x16x32_bf16 v[204:207], a[88:91], v[48:51], 0
  ds_read_b64_tr_b16 a[84:85], v15 offset:8192
  s_waitcnt lgkmcnt(5)
  v_mfma_f32_16x16x32_bf16 v[208:211], a[72:75], v[40:43], v[208:211]
  v_exp_f32 v97, v97
  v_mfma_f32_16x16x32_bf16 v[212:215], a[72:75], v[44:47], v[212:215]
  ds_read_b64_tr_b16 a[86:87], v15 offset:10240
  buffer_load_dwordx4 v16, s[20:23], s31 offen offset:2048 lds
  v_mfma_f32_16x16x32_bf16 v[216:219], a[72:75], v[48:51], v[216:219]
  s_waitcnt lgkmcnt(4)
  v_mfma_f32_16x16x32_bf16 v[220:223], a[76:79], v[40:43], 0
  v_exp_f32 v98, v98
  v_mfma_f32_16x16x32_bf16 v[224:227], a[76:79], v[44:47], 0
  v_cvt_pk_bf16_f32 v60, v96, v97
  v_mfma_f32_16x16x32_bf16 v[228:231], a[76:79], v[48:51], 0
  s_waitcnt vmcnt(11)
  ds_read_b128 a[88:91], v10 offset:24576
  s_waitcnt lgkmcnt(3)
  v_mfma_f32_16x16x32_bf16 v[232:235], a[80:83], v[40:43], 0
  v_exp_f32 v99, v99
  v_mfma_f32_16x16x32_bf16 v[236:239], a[80:83], v[44:47], 0
  buffer_load_dwordx4 v16, s[20:23], s31 offen offset:3072 lds
  v_mfma_f32_16x16x32_bf16 v[240:243], a[80:83], v[48:51], 0
  ds_read_b128 a[72:75], v10 offset:26624
  s_waitcnt lgkmcnt(2)
  v_mfma_f32_16x16x32_bf16 v[244:247], a[84:87], v[40:43], 0
  v_exp_f32 v100, v100
  v_mfma_f32_16x16x32_bf16 v[248:251], a[84:87], v[44:47], 0
  v_cvt_pk_bf16_f32 v61, v98, v99
  v_mfma_f32_16x16x32_bf16 v[252:255], a[84:87], v[48:51], 0
  ds_read_b128 a[76:79], v11 offset:24576
  v_mfma_f32_16x16x32_bf16 a[104:107], a[116:119], v[40:43], a[104:107]
  v_exp_f32 v101, v101
  v_mfma_f32_16x16x32_bf16 a[108:111], a[116:119], v[44:47], a[108:111]
  s_add_u32 m0, s30, 4096
  s_nop 0
  buffer_load_dwordx4 v17, s[20:23], s31 offen offset:0 lds
  v_mfma_f32_16x16x32_bf16 a[112:115], a[116:119], v[48:51], a[112:115]
  ds_read_b128 a[80:83], v11 offset:26624
  s_waitcnt lgkmcnt(3)
  v_mfma_f32_16x16x32_bf16 v[64:67], a[88:91], a[0:3], v[28:31]
  v_exp_f32 v102, v102
  v_mfma_f32_16x16x32_bf16 v[68:71], a[88:91], a[24:27], v[32:35]
  v_cvt_pk_bf16_f32 v54, v100, v101
  v_mfma_f32_16x16x32_bf16 v[72:75], a[88:91], a[48:51], v[36:39]
  s_waitcnt vmcnt(9)
  ds_read_b128 a[84:87], v10 offset:28672
  s_waitcnt lgkmcnt(3)
  v_mfma_f32_16x16x32_bf16 v[76:79], a[72:75], a[0:3], v[28:31]
  v_exp_f32 v103, v103
  v_mfma_f32_16x16x32_bf16 v[80:83], a[72:75], a[24:27], v[32:35]
  buffer_load_dwordx4 v17, s[20:23], s31 offen offset:1024 lds
  v_mfma_f32_16x16x32_bf16 v[84:87], a[72:75], a[48:51], v[36:39]
  ds_read_b128 a[88:91], v10 offset:30720
  s_waitcnt lgkmcnt(3)
  v_mfma_f32_16x16x32_bf16 v[64:67], a[76:79], a[4:7], v[64:67]
  v_exp_f32 v104, v104
  v_mfma_f32_16x16x32_bf16 v[68:71], a[76:79], a[28:31], v[68:71]
  v_cvt_pk_bf16_f32 v55, v102, v103
  v_mfma_f32_16x16x32_bf16 v[72:75], a[76:79], a[52:55], v[72:75]
  ds_read_b128 a[72:75], v11 offset:28672
  s_waitcnt lgkmcnt(3)
  v_mfma_f32_16x16x32_bf16 v[76:79], a[80:83], a[4:7], v[76:79]
  v_exp_f32 v105, v105
  v_mfma_f32_16x16x32_bf16 v[80:83], a[80:83], a[28:31], v[80:83]
  buffer_load_dwordx4 v17, s[20:23], s31 offen offset:2048 lds
  v_mfma_f32_16x16x32_bf16 v[84:87], a[80:83], a[52:55], v[84:87]
  ds_read_b128 a[76:79], v11 offset:30720
  s_waitcnt lgkmcnt(3)
  v_mfma_f32_16x16x32_bf16 v[64:67], a[84:87], a[8:11], v[64:67]
  v_exp_f32 v106, v106
  v_mfma_f32_16x16x32_bf16 v[68:71], a[84:87], a[32:35], v[68:71]
  v_cvt_pk_bf16_f32 v58, v104, v105
  v_mfma_f32_16x16x32_bf16 v[72:75], a[84:87], a[56:59], v[72:75]
  s_waitcnt vmcnt(7)
  ds_read_b128 a[80:83], v10 offset:32768
  s_waitcnt lgkmcnt(3)
  v_mfma_f32_16x16x32_bf16 v[76:79], a[88:91], a[8:11], v[76:79]
  v_exp_f32 v107, v107
  v_mfma_f32_16x16x32_bf16 v[80:83], a[88:91], a[32:35], v[80:83]
  buffer_load_dwordx4 v17, s[20:23], s31 offen offset:3072 lds
  v_mfma_f32_16x16x32_bf16 v[84:87], a[88:91], a[56:59], v[84:87]
  ds_read_b128 a[84:87], v10 offset:34816
  s_waitcnt lgkmcnt(3)
  v_mfma_f32_16x16x32_bf16 v[64:67], a[72:75], a[12:15], v[64:67]
  v_exp_f32 v108, v108
  v_mfma_f32_16x16x32_bf16 v[68:71], a[72:75], a[36:39], v[68:71]
  v_cvt_pk_bf16_f32 v59, v106, v107
  v_mfma_f32_16x16x32_bf16 v[72:75], a[72:75], a[60:63], v[72:75]
  ds_read_b128 a[88:91], v11 offset:32768
  s_waitcnt lgkmcnt(3)
  v_mfma_f32_16x16x32_bf16 v[76:79], a[76:79], a[12:15], v[76:79]
  v_exp_f32 v109, v109
  v_mfma_f32_16x16x32_bf16 v[80:83], a[76:79], a[36:39], v[80:83]
  s_add_u32 m0, s30, 8192
  s_nop 0
  buffer_load_dwordx4 v18, s[20:23], s31 offen offset:0 lds
  v_mfma_f32_16x16x32_bf16 v[84:87], a[76:79], a[60:63], v[84:87]
  ds_read_b128 a[72:75], v11 offset:34816
  s_waitcnt lgkmcnt(3)
  v_mfma_f32_16x16x32_bf16 v[64:67], a[80:83], a[16:19], v[64:67]
  v_exp_f32 v110, v110
  v_mfma_f32_16x16x32_bf16 v[68:71], a[80:83], a[40:43], v[68:71]
  v_cvt_pk_bf16_f32 v62, v108, v109
  v_mfma_f32_16x16x32_bf16 v[72:75], a[80:83], a[64:67], v[72:75]
  ds_read_b64_tr_b16 a[76:77], v12 offset:12288
  s_waitcnt lgkmcnt(3)
  v_mfma_f32_16x16x32_bf16 v[76:79], a[84:87], a[16:19], v[76:79]
  v_exp_f32 v111, v111
  v_mfma_f32_16x16x32_bf16 v[80:83], a[84:87], a[40:43], v[80:83]
  ds_read_b64_tr_b16 a[78:79], v12 offset:14336
  buffer_load_dwordx4 v18, s[20:23], s31 offen offset:1024 lds
  v_mfma_f32_16x16x32_bf16 v[84:87], a[84:87], a[64:67], v[84:87]
  ds_read_b64_tr_b16 a[80:81], v13 offset:12288
  s_waitcnt lgkmcnt(4)
  v_mfma_f32_16x16x32_bf16 v[64:67], a[88:91], a[20:23], v[64:67]
  v_cvt_pk_bf16_f32 v63, v110, v111
  v_mfma_f32_16x16x32_bf16 v[68:71], a[88:91], a[44:47], v[68:71]
  ds_read_b64_tr_b16 a[82:83], v13 offset:14336
  v_mfma_f32_16x16x32_bf16 v[72:75], a[88:91], a[68:71], v[72:75]
  ds_read_b64_tr_b16 a[84:85], v14 offset:12288
  s_waitcnt lgkmcnt(5)
  v_mfma_f32_16x16x32_bf16 v[76:79], a[72:75], a[20:23], v[76:79]
  v_mfma_f32_16x16x32_bf16 v[80:83], a[72:75], a[44:47], v[80:83]
  ds_read_b64_tr_b16 a[86:87], v14 offset:14336
  buffer_load_dwordx4 v18, s[20:23], s31 offen offset:2048 lds
  v_mfma_f32_16x16x32_bf16 v[84:87], a[72:75], a[68:71], v[84:87]
  ds_read_b64_tr_b16 a[88:89], v15 offset:12288
  s_waitcnt lgkmcnt(5)
  v_mfma_f32_16x16x32_bf16 v[112:115], a[76:79], v[52:55], v[112:115]
  v_exp_f32 v64, v64
  v_mfma_f32_16x16x32_bf16 v[116:119], a[76:79], v[56:59], v[116:119]
  ds_read_b64_tr_b16 a[90:91], v15 offset:14336
  v_exp_f32 v65, v65
  v_mfma_f32_16x16x32_bf16 v[120:123], a[76:79], v[60:63], v[120:123]
  ds_read_b64_tr_b16 a[72:73], v12 offset:16384
  s_waitcnt lgkmcnt(5)
  v_mfma_f32_16x16x32_bf16 v[124:127], a[80:83], v[52:55], v[124:127]
  v_exp_f32 v66, v66
  v_mfma_f32_16x16x32_bf16 v[128:131], a[80:83], v[56:59], v[128:131]
  ds_read_b64_tr_b16 a[74:75], v12 offset:18432
  buffer_load_dwordx4 v18, s[20:23], s31 offen offset:3072 lds
  v_cvt_pk_bf16_f32 v40, v64, v65
  v_mfma_f32_16x16x32_bf16 v[132:135], a[80:83], v[60:63], v[132:135]
  ds_read_b64_tr_b16 a[76:77], v13 offset:16384
  s_waitcnt lgkmcnt(5)
  v_mfma_f32_16x16x32_bf16 v[136:139], a[84:87], v[52:55], v[136:139]
  v_exp_f32 v67, v67
  v_mfma_f32_16x16x32_bf16 v[140:143], a[84:87], v[56:59], v[140:143]
  ds_read_b64_tr_b16 a[78:79], v13 offset:18432
  s_add_u32 s31, s31, 12288
  s_cmp_eq_u32 s31, s33
  s_cselect_b32 s31, s34, s31
  v_mfma_f32_16x16x32_bf16 v[144:147], a[84:87], v[60:63], v[144:147]
  ds_read_b64_tr_b16 a[80:81], v14 offset:16384
  s_waitcnt lgkmcnt(5)
  v_mfma_f32_16x16x32_bf16 v[148:151], a[88:91], v[52:55], v[148:151]
  v_exp_f32 v68, v68
  v_mfma_f32_16x16x32_bf16 v[152:155], a[88:91], v[56:59], v[152:155]
  ds_read_b64_tr_b16 a[82:83], v14 offset:18432
  v_cvt_pk_bf16_f32 v41, v66, v67
  v_mfma_f32_16x16x32_bf16 v[156:159], a[88:91], v[60:63], v[156:159]
  ds_read_b64_tr_b16 a[84:85], v15 offset:16384
  s_waitcnt lgkmcnt(5)
  v_mfma_f32_16x16x32_bf16 v[160:163], a[72:75], v[52:55], v[160:163]
  v_exp_f32 v69, v69
  v_mfma_f32_16x16x32_bf16 v[164:167], a[72:75], v[56:59], v[164:167]
  ds_read_b64_tr_b16 a[86:87], v15 offset:18432
  s_add_u32 m0, s30, 12288
  s_nop 0
  buffer_load_dwordx4 v16, s[20:23], s31 offen offset:0 lds
  v_mfma_f32_16x16x32_bf16 v[168:171], a[72:75], v[60:63], v[168:171]
  ds_read_b64_tr_b16 a[88:89], v12 offset:20480
  s_waitcnt lgkmcnt(5)
  v_mfma_f32_16x16x32_bf16 v[172:175], a[76:79], v[52:55], v[172:175]
  v_exp_f32 v70, v70
  v_mfma_f32_16x16x32_bf16 v[176:179], a[76:79], v[56:59], v[176:179]
  ds_read_b64_tr_b16 a[90:91], v12 offset:22528
  v_cvt_pk_bf16_f32 v44, v68, v69
  v_mfma_f32_16x16x32_bf16 v[180:183], a[76:79], v[60:63], v[180:183]
  ds_read_b64_tr_b16 a[72:73], v13 offset:20480
  s_waitcnt lgkmcnt(5)
  v_mfma_f32_16x16x32_bf16 v[184:187], a[80:83], v[52:55], v[184:187]
  v_exp_f32 v71, v71
  v_mfma_f32_16x16x32_bf16 v[188:191], a[80:83], v[56:59], v[188:191]
  ds_read_b64_tr_b16 a[74:75], v13 offset:22528
  buffer_load_dwordx4 v16, s[20:23], s31 offen offset:1024 lds
  v_mfma_f32_16x16x32_bf16 v[192:195], a[80:83], v[60:63], v[192:195]
  ds_read_b64_tr_b16 a[76:77], v14 offset:20480
  s_waitcnt lgkmcnt(5)
  v_mfma_f32_16x16x32_bf16 v[196:199], a[84:87], v[52:55], v[196:199]
  v_exp_f32 v72, v72
  v_mfma_f32_16x16x32_bf16 v[200:203], a[84:87], v[56:59], v[200:203]
  ds_read_b64_tr_b16 a[78:79], v14 offset:22528
  v_cvt_pk_bf16_f32 v45, v70, v71
  v_mfma_f32_16x16x32_bf16 v[204:207], a[84:87], v[60:63], v[204:207]
  ds_read_b64_tr_b16 a[80:81], v15 offset:20480
  s_waitcnt lgkmcnt(5)
  v_mfma_f32_16x16x32_bf16 v[208:211], a[88:91], v[52:55], v[208:211]
  v_exp_f32 v73, v73
  v_mfma_f32_16x16x32_bf16 v[212:215], a[88:91], v[56:59], v[212:215]
  ds_read_b64_tr_b16 a[82:83], v15 offset:22528
  buffer_load_dwordx4 v16, s[20:23], s31 offen offset:2048 lds
  v_mfma_f32_16x16x32_bf16 v[216:219], a[88:91], v[60:63], v[216:219]
  s_waitcnt lgkmcnt(4)
  v_mfma_f32_16x16x32_bf16 v[220:223], a[72:75], v[52:55], v[220:223]
  v_exp_f32 v74, v74
  v_mfma_f32_16x16x32_bf16 v[224:227], a[72:75], v[56:59], v[224:227]
  v_cvt_pk_bf16_f32 v48, v72, v73
  v_mfma_f32_16x16x32_bf16 v[228:231], a[72:75], v[60:63], v[228:231]
  s_waitcnt vmcnt(11)
  ds_read_b128 a[84:87], v10 offset:0
  s_waitcnt lgkmcnt(3)
  v_mfma_f32_16x16x32_bf16 v[232:235], a[76:79], v[52:55], v[232:235]
  v_exp_f32 v75, v75
  v_mfma_f32_16x16x32_bf16 v[236:239], a[76:79], v[56:59], v[236:239]
  buffer_load_dwordx4 v16, s[20:23], s31 offen offset:3072 lds
  v_mfma_f32_16x16x32_bf16 v[240:243], a[76:79], v[60:63], v[240:243]
  ds_read_b128 a[88:91], v10 offset:2048
  s_waitcnt lgkmcnt(2)
  v_mfma_f32_16x16x32_bf16 v[244:247], a[80:83], v[52:55], v[244:247]
  v_exp_f32 v76, v76
  v_mfma_f32_16x16x32_bf16 v[248:251], a[80:83], v[56:59], v[248:251]
  v_cvt_pk_bf16_f32 v49, v74, v75
  v_mfma_f32_16x16x32_bf16 v[252:255], a[80:83], v[60:63], v[252:255]
  ds_read_b128 a[72:75], v11 offset:0
  v_mfma_f32_16x16x32_bf16 a[104:107], a[116:119], v[52:55], a[104:107]
  v_exp_f32 v77, v77
  v_mfma_f32_16x16x32_bf16 a[108:111], a[116:119], v[56:59], a[108:111]
  s_add_u32 m0, s30, 16384
  s_nop 0
  buffer_load_dwordx4 v17, s[20:23], s31 offen offset:0 lds
  v_mfma_f32_16x16x32_bf16 a[112:115], a[116:119], v[60:63], a[112:115]
  ds_read_b128 a[76:79], v11 offset:2048
  s_waitcnt lgkmcnt(3)
  v_mfma_f32_16x16x32_bf16 v[88:91], a[84:87], a[0:3], v[28:31]
  v_exp_f32 v78, v78
  v_mfma_f32_16x16x32_bf16 v[92:95], a[84:87], a[24:27], v[32:35]
  v_cvt_pk_bf16_f32 v42, v76, v77
  v_mfma_f32_16x16x32_bf16 v[96:99], a[84:87], a[48:51], v[36:39]
  s_waitcnt vmcnt(9)
  ds_read_b128 a[80:83], v10 offset:4096
  s_waitcnt lgkmcnt(3)
  v_mfma_f32_16x16x32_bf16 v[100:103], a[88:91], a[0:3], v[28:31]
  v_exp_f32 v79, v79
  v_mfma_f32_16x16x32_bf16 v[104:107], a[88:91], a[24:27], v[32:35]
  buffer_load_dwordx4 v17, s[20:23], s31 offen offset:1024 lds
  v_mfma_f32_16x16x32_bf16 v[108:111], a[88:91], a[48:51], v[36:39]
  ds_read_b128 a[84:87], v10 offset:6144
  s_waitcnt lgkmcnt(3)
  v_mfma_f32_16x16x32_bf16 v[88:91], a[72:75], a[4:7], v[88:91]
  v_exp_f32 v80, v80
  v_mfma_f32_16x16x32_bf16 v[92:95], a[72:75], a[28:31], v[92:95]
  v_cvt_pk_bf16_f32 v43, v78, v79
  v_mfma_f32_16x16x32_bf16 v[96:99], a[72:75], a[52:55], v[96:99]
  ds_read_b128 a[88:91], v11 offset:4096
  s_waitcnt lgkmcnt(3)
  v_mfma_f32_16x16x32_bf16 v[100:103], a[76:79], a[4:7], v[100:103]
  v_exp_f32 v81, v81
  v_mfma_f32_16x16x32_bf16 v[104:107], a[76:79], a[28:31], v[104:107]
  buffer_load_dwordx4 v17, s[20:23], s31 offen offset:2048 lds
  v_mfma_f32_16x16x32_bf16 v[108:111], a[76:79], a[52:55], v[108:111]
  ds_read_b128 a[72:75], v11 offset:6144
  s_waitcnt lgkmcnt(3)
  v_mfma_f32_16x16x32_bf16 v[88:91], a[80:83], a[8:11], v[88:91]
  v_exp_f32 v82, v82
  v_mfma_f32_16x16x32_bf16 v[92:95], a[80:83], a[32:35], v[92:95]
  v_cvt_pk_bf16_f32 v46, v80, v81
  v_mfma_f32_16x16x32_bf16 v[96:99], a[80:83], a[56:59], v[96:99]
  s_waitcnt vmcnt(7)
  ds_read_b128 a[76:79], v10 offset:8192
  s_waitcnt lgkmcnt(3)
  v_mfma_f32_16x16x32_bf16 v[100:103], a[84:87], a[8:11], v[100:103]
  v_exp_f32 v83, v83
  v_mfma_f32_16x16x32_bf16 v[104:107], a[84:87], a[32:35], v[104:107]
  buffer_load_dwordx4 v17, s[20:23], s31 offen offset:3072 lds
  v_mfma_f32_16x16x32_bf16 v[108:111], a[84:87], a[56:59], v[108:111]
  ds_read_b128 a[80:83], v10 offset:10240
  s_waitcnt lgkmcnt(3)
  v_mfma_f32_16x16x32_bf16 v[88:91], a[88:91], a[12:15], v[88:91]
  v_exp_f32 v84, v84
  v_mfma_f32_16x16x32_bf16 v[92:95], a[88:91], a[36:39], v[92:95]
  v_cvt_pk_bf16_f32 v47, v82, v83
  v_mfma_f32_16x16x32_bf16 v[96:99], a[88:91], a[60:63], v[96:99]
  ds_read_b128 a[84:87], v11 offset:8192
  s_waitcnt lgkmcnt(3)
  v_mfma_f32_16x16x32_bf16 v[100:103], a[72:75], a[12:15], v[100:103]
  v_exp_f32 v85, v85
  v_mfma_f32_16x16x32_bf16 v[104:107], a[72:75], a[36:39], v[104:107]
  s_add_u32 m0, s30, 20480
  s_nop 0
  buffer_load_dwordx4 v18, s[20:23], s31 offen offset:0 lds
  v_mfma_f32_16x16x32_bf16 v[108:111], a[72:75], a[60:63], v[108:111]
  ds_read_b128 a[88:91], v11 offset:10240
  s_waitcnt lgkmcnt(3)
  v_mfma_f32_16x16x32_bf16 v[88:91], a[76:79], a[16:19], v[88:91]
  v_exp_f32 v86, v86
  v_mfma_f32_16x16x32_bf16 v[92:95], a[76:79], a[40:43], v[92:95]
  v_cvt_pk_bf16_f32 v50, v84, v85
  v_mfma_f32_16x16x32_bf16 v[96:99], a[76:79], a[64:67], v[96:99]
  ds_read_b64_tr_b16 a[72:73], v12 offset:24576
  s_waitcnt lgkmcnt(3)
  v_mfma_f32_16x16x32_bf16 v[100:103], a[80:83], a[16:19], v[100:103]
  v_exp_f32 v87, v87
  v_mfma_f32_16x16x32_bf16 v[104:107], a[80:83], a[40:43], v[104:107]
  ds_read_b64_tr_b16 a[74:75], v12 offset:26624
  buffer_load_dwordx4 v18, s[20:23], s31 offen offset:1024 lds
  v_mfma_f32_16x16x32_bf16 v[108:111], a[80:83], a[64:67], v[108:111]
  ds_read_b64_tr_b16 a[76:77], v13 offset:24576
  s_waitcnt lgkmcnt(4)
  v_mfma_f32_16x16x32_bf16 v[88:91], a[84:87], a[20:23], v[88:91]
  v_cvt_pk_bf16_f32 v51, v86, v87
  v_mfma_f32_16x16x32_bf16 v[92:95], a[84:87], a[44:47], v[92:95]
  ds_read_b64_tr_b16 a[78:79], v13 offset:26624
  v_mfma_f32_16x16x32_bf16 v[96:99], a[84:87], a[68:71], v[96:99]
  ds_read_b64_tr_b16 a[80:81], v14 offset:24576
  s_waitcnt lgkmcnt(5)
  v_mfma_f32_16x16x32_bf16 v[100:103], a[88:91], a[20:23], v[100:103]
  v_mfma_f32_16x16x32_bf16 v[104:107], a[88:91], a[44:47], v[104:107]
  ds_read_b64_tr_b16 a[82:83], v14 offset:26624
  buffer_load_dwordx4 v18, s[20:23], s31 offen offset:2048 lds
  v_mfma_f32_16x16x32_bf16 v[108:111], a[88:91], a[68:71], v[108:111]
  ds_read_b64_tr_b16 a[84:85], v15 offset:24576
  s_waitcnt lgkmcnt(5)
  v_mfma_f32_16x16x32_bf16 v[112:115], a[72:75], v[40:43], v[112:115]
  v_exp_f32 v88, v88
  v_mfma_f32_16x16x32_bf16 v[116:119], a[72:75], v[44:47], v[116:119]
  ds_read_b64_tr_b16 a[86:87], v15 offset:26624
  v_exp_f32 v89, v89
  v_mfma_f32_16x16x32_bf16 v[120:123], a[72:75], v[48:51], v[120:123]
  ds_read_b64_tr_b16 a[88:89], v12 offset:28672
  s_waitcnt lgkmcnt(5)
  v_mfma_f32_16x16x32_bf16 v[124:127], a[76:79], v[40:43], v[124:127]
  v_exp_f32 v90, v90
  v_mfma_f32_16x16x32_bf16 v[128:131], a[76:79], v[44:47], v[128:131]
  ds_read_b64_tr_b16 a[90:91], v12 offset:30720
  buffer_load_dwordx4 v18, s[20:23], s31 offen offset:3072 lds
  v_cvt_pk_bf16_f32 v52, v88, v89
  v_mfma_f32_16x16x32_bf16 v[132:135], a[76:79], v[48:51], v[132:135]
  ds_read_b64_tr_b16 a[72:73], v13 offset:28672
  s_waitcnt lgkmcnt(5)
  v_mfma_f32_16x16x32_bf16 v[136:139], a[80:83], v[40:43], v[136:139]
  v_exp_f32 v91, v91
  v_mfma_f32_16x16x32_bf16 v[140:143], a[80:83], v[44:47], v[140:143]
  ds_read_b64_tr_b16 a[74:75], v13 offset:30720
  s_add_u32 s31, s31, 12288
  s_cmp_eq_u32 s31, s33
  s_cselect_b32 s31, s34, s31
  v_mfma_f32_16x16x32_bf16 v[144:147], a[80:83], v[48:51], v[144:147]
  ds_read_b64_tr_b16 a[76:77], v14 offset:28672
  s_waitcnt lgkmcnt(5)
  v_mfma_f32_16x16x32_bf16 v[148:151], a[84:87], v[40:43], v[148:151]
  v_exp_f32 v92, v92
  v_mfma_f32_16x16x32_bf16 v[152:155], a[84:87], v[44:47], v[152:155]
  ds_read_b64_tr_b16 a[78:79], v14 offset:30720
  v_cvt_pk_bf16_f32 v53, v90, v91
  v_mfma_f32_16x16x32_bf16 v[156:159], a[84:87], v[48:51], v[156:159]
  ds_read_b64_tr_b16 a[80:81], v15 offset:28672
  s_waitcnt lgkmcnt(5)
  v_mfma_f32_16x16x32_bf16 v[160:163], a[88:91], v[40:43], v[160:163]
  v_exp_f32 v93, v93
  v_mfma_f32_16x16x32_bf16 v[164:167], a[88:91], v[44:47], v[164:167]
  ds_read_b64_tr_b16 a[82:83], v15 offset:30720
  s_add_u32 m0, s30, 24576
  s_nop 0
  buffer_load_dwordx4 v16, s[20:23], s31 offen offset:0 lds
  v_mfma_f32_16x16x32_bf16 v[168:171], a[88:91], v[48:51], v[168:171]
  ds_read_b64_tr_b16 a[84:85], v12 offset:32768
  s_waitcnt lgkmcnt(5)
  v_mfma_f32_16x16x32_bf16 v[172:175], a[72:75], v[40:43], v[172:175]
  v_exp_f32 v94, v94
  v_mfma_f32_16x16x32_bf16 v[176:179], a[72:75], v[44:47], v[176:179]
  ds_read_b64_tr_b16 a[86:87], v12 offset:34816
  v_cvt_pk_bf16_f32 v56, v92, v93
  v_mfma_f32_16x16x32_bf16 v[180:183], a[72:75], v[48:51], v[180:183]
  ds_read_b64_tr_b16 a[88:89], v13 offset:32768
  s_waitcnt lgkmcnt(5)
  v_mfma_f32_16x16x32_bf16 v[184:187], a[76:79], v[40:43], v[184:187]
  v_exp_f32 v95, v95
  v_mfma_f32_16x16x32_bf16 v[188:191], a[76:79], v[44:47], v[188:191]
  ds_read_b64_tr_b16 a[90:91], v13 offset:34816
  buffer_load_dwordx4 v16, s[20:23], s31 offen offset:1024 lds
  v_mfma_f32_16x16x32_bf16 v[192:195], a[76:79], v[48:51], v[192:195]
  ds_read_b64_tr_b16 a[72:73], v14 offset:32768
  s_waitcnt lgkmcnt(5)
  v_mfma_f32_16x16x32_bf16 v[196:199], a[80:83], v[40:43], v[196:199]
  v_exp_f32 v96, v96
  v_mfma_f32_16x16x32_bf16 v[200:203], a[80:83], v[44:47], v[200:203]
  ds_read_b64_tr_b16 a[74:75], v14 offset:34816
  v_cvt_pk_bf16_f32 v57, v94, v95
  v_mfma_f32_16x16x32_bf16 v[204:207], a[80:83], v[48:51], v[204:207]
  ds_read_b64_tr_b16 a[76:77], v15 offset:32768
  s_waitcnt lgkmcnt(5)
  v_mfma_f32_16x16x32_bf16 v[208:211], a[84:87], v[40:43], v[208:211]
  v_exp_f32 v97, v97
  v_mfma_f32_16x16x32_bf16 v[212:215], a[84:87], v[44:47], v[212:215]
  ds_read_b64_tr_b16 a[78:79], v15 offset:34816
  buffer_load_dwordx4 v16, s[20:23], s31 offen offset:2048 lds
  v_mfma_f32_16x16x32_bf16 v[216:219], a[84:87], v[48:51], v[216:219]
  s_waitcnt lgkmcnt(4)
  v_mfma_f32_16x16x32_bf16 v[220:223], a[88:91], v[40:43], v[220:223]
  v_exp_f32 v98, v98
  v_mfma_f32_16x16x32_bf16 v[224:227], a[88:91], v[44:47], v[224:227]
  v_cvt_pk_bf16_f32 v60, v96, v97
  v_mfma_f32_16x16x32_bf16 v[228:231], a[88:91], v[48:51], v[228:231]
  s_waitcnt vmcnt(11)
  ds_read_b128 a[80:83], v10 offset:12288
  s_waitcnt lgkmcnt(3)
  v_mfma_f32_16x16x32_bf16 v[232:235], a[72:75], v[40:43], v[232:235]
  v_exp_f32 v99, v99
  v_mfma_f32_16x16x32_bf16 v[236:239], a[72:75], v[44:47], v[236:239]
  buffer_load_dwordx4 v16, s[20:23], s31 offen offset:3072 lds
  v_mfma_f32_16x16x32_bf16 v[240:243], a[72:75], v[48:51], v[240:243]
  ds_read_b128 a[84:87], v10 offset:14336
  s_waitcnt lgkmcnt(2)
  v_mfma_f32_16x16x32_bf16 v[244:247], a[76:79], v[40:43], v[244:247]
  v_exp_f32 v100, v100
  v_mfma_f32_16x16x32_bf16 v[248:251], a[76:79], v[44:47], v[248:251]
  v_cvt_pk_bf16_f32 v61, v98, v99
  v_mfma_f32_16x16x32_bf16 v[252:255], a[76:79], v[48:51], v[252:255]
  ds_read_b128 a[88:91], v11 offset:12288
  v_mfma_f32_16x16x32_bf16 a[104:107], a[116:119], v[40:43], a[104:107]
  v_exp_f32 v101, v101
  v_mfma_f32_16x16x32_bf16 a[108:111], a[116:119], v[44:47], a[108:111]
  s_add_u32 m0, s30, 28672
  s_nop 0
  buffer_load_dwordx4 v17, s[20:23], s31 offen offset:0 lds
  v_mfma_f32_16x16x32_bf16 a[112:115], a[116:119], v[48:51], a[112:115]
  ds_read_b128 a[72:75], v11 offset:14336
  s_waitcnt lgkmcnt(3)
  v_mfma_f32_16x16x32_bf16 v[64:67], a[80:83], a[0:3], v[28:31]
  v_exp_f32 v102, v102
  v_mfma_f32_16x16x32_bf16 v[68:71], a[80:83], a[24:27], v[32:35]
  v_cvt_pk_bf16_f32 v54, v100, v101
  v_mfma_f32_16x16x32_bf16 v[72:75], a[80:83], a[48:51], v[36:39]
  s_waitcnt vmcnt(9)
  ds_read_b128 a[76:79], v10 offset:16384
  s_waitcnt lgkmcnt(3)
  v_mfma_f32_16x16x32_bf16 v[76:79], a[84:87], a[0:3], v[28:31]
  v_exp_f32 v103, v103
  v_mfma_f32_16x16x32_bf16 v[80:83], a[84:87], a[24:27], v[32:35]
  buffer_load_dwordx4 v17, s[20:23], s31 offen offset:1024 lds
  v_mfma_f32_16x16x32_bf16 v[84:87], a[84:87], a[48:51], v[36:39]
  ds_read_b128 a[80:83], v10 offset:18432
  s_waitcnt lgkmcnt(3)
  v_mfma_f32_16x16x32_bf16 v[64:67], a[88:91], a[4:7], v[64:67]
  v_exp_f32 v104, v104
  v_mfma_f32_16x16x32_bf16 v[68:71], a[88:91], a[28:31], v[68:71]
  v_cvt_pk_bf16_f32 v55, v102, v103
  v_mfma_f32_16x16x32_bf16 v[72:75], a[88:91], a[52:55], v[72:75]
  ds_read_b128 a[84:87], v11 offset:16384
  s_waitcnt lgkmcnt(3)
  v_mfma_f32_16x16x32_bf16 v[76:79], a[72:75], a[4:7], v[76:79]
  v_exp_f32 v105, v105
  v_mfma_f32_16x16x32_bf16 v[80:83], a[72:75], a[28:31], v[80:83]
  buffer_load_dwordx4 v17, s[20:23], s31 offen offset:2048 lds
  v_mfma_f32_16x16x32_bf16 v[84:87], a[72:75], a[52:55], v[84:87]
  ds_read_b128 a[88:91], v11 offset:18432
  s_waitcnt lgkmcnt(3)
  v_mfma_f32_16x16x32_bf16 v[64:67], a[76:79], a[8:11], v[64:67]
  v_exp_f32 v106, v106
  v_mfma_f32_16x16x32_bf16 v[68:71], a[76:79], a[32:35], v[68:71]
  v_cvt_pk_bf16_f32 v58, v104, v105
  v_mfma_f32_16x16x32_bf16 v[72:75], a[76:79], a[56:59], v[72:75]
  s_waitcnt vmcnt(7)
  ds_read_b128 a[72:75], v10 offset:20480
  s_waitcnt lgkmcnt(3)
  v_mfma_f32_16x16x32_bf16 v[76:79], a[80:83], a[8:11], v[76:79]
  v_exp_f32 v107, v107
  v_mfma_f32_16x16x32_bf16 v[80:83], a[80:83], a[32:35], v[80:83]
  buffer_load_dwordx4 v17, s[20:23], s31 offen offset:3072 lds
  v_mfma_f32_16x16x32_bf16 v[84:87], a[80:83], a[56:59], v[84:87]
  ds_read_b128 a[76:79], v10 offset:22528
  s_waitcnt lgkmcnt(3)
  v_mfma_f32_16x16x32_bf16 v[64:67], a[84:87], a[12:15], v[64:67]
  v_exp_f32 v108, v108
  v_mfma_f32_16x16x32_bf16 v[68:71], a[84:87], a[36:39], v[68:71]
  v_cvt_pk_bf16_f32 v59, v106, v107
  v_mfma_f32_16x16x32_bf16 v[72:75], a[84:87], a[60:63], v[72:75]
  ds_read_b128 a[80:83], v11 offset:20480
  s_waitcnt lgkmcnt(3)
  v_mfma_f32_16x16x32_bf16 v[76:79], a[88:91], a[12:15], v[76:79]
  v_exp_f32 v109, v109
  v_mfma_f32_16x16x32_bf16 v[80:83], a[88:91], a[36:39], v[80:83]
  s_add_u32 m0, s30, 32768
  s_nop 0
  buffer_load_dwordx4 v18, s[20:23], s31 offen offset:0 lds
  v_mfma_f32_16x16x32_bf16 v[84:87], a[88:91], a[60:63], v[84:87]
  ds_read_b128 a[84:87], v11 offset:22528
  s_waitcnt lgkmcnt(3)
  v_mfma_f32_16x16x32_bf16 v[64:67], a[72:75], a[16:19], v[64:67]
  v_exp_f32 v110, v110
  v_mfma_f32_16x16x32_bf16 v[68:71], a[72:75], a[40:43], v[68:71]
  v_cvt_pk_bf16_f32 v62, v108, v109
  v_mfma_f32_16x16x32_bf16 v[72:75], a[72:75], a[64:67], v[72:75]
  ds_read_b64_tr_b16 a[88:89], v12 offset:0
  s_waitcnt lgkmcnt(3)
  v_mfma_f32_16x16x32_bf16 v[76:79], a[76:79], a[16:19], v[76:79]
  v_exp_f32 v111, v111
  v_mfma_f32_16x16x32_bf16 v[80:83], a[76:79], a[40:43], v[80:83]
  ds_read_b64_tr_b16 a[90:91], v12 offset:2048
  buffer_load_dwordx4 v18, s[20:23], s31 offen offset:1024 lds
  v_mfma_f32_16x16x32_bf16 v[84:87], a[76:79], a[64:67], v[84:87]
  ds_read_b64_tr_b16 a[72:73], v13 offset:0
  s_waitcnt lgkmcnt(4)
  v_mfma_f32_16x16x32_bf16 v[64:67], a[80:83], a[20:23], v[64:67]
  v_cvt_pk_bf16_f32 v63, v110, v111
  v_mfma_f32_16x16x32_bf16 v[68:71], a[80:83], a[44:47], v[68:71]
  ds_read_b64_tr_b16 a[74:75], v13 offset:2048
  v_mfma_f32_16x16x32_bf16 v[72:75], a[80:83], a[68:71], v[72:75]
  ds_read_b64_tr_b16 a[76:77], v14 offset:0
  s_waitcnt lgkmcnt(5)
  v_mfma_f32_16x16x32_bf16 v[76:79], a[84:87], a[20:23], v[76:79]
  v_mfma_f32_16x16x32_bf16 v[80:83], a[84:87], a[44:47], v[80:83]
  ds_read_b64_tr_b16 a[78:79], v14 offset:2048
  buffer_load_dwordx4 v18, s[20:23], s31 offen offset:2048 lds
  v_mfma_f32_16x16x32_bf16 v[84:87], a[84:87], a[68:71], v[84:87]
  ds_read_b64_tr_b16 a[80:81], v15 offset:0
  s_waitcnt lgkmcnt(5)
  v_mfma_f32_16x16x32_bf16 v[112:115], a[88:91], v[52:55], v[112:115]
  v_exp_f32 v64, v64
  v_mfma_f32_16x16x32_bf16 v[116:119], a[88:91], v[56:59], v[116:119]
  ds_read_b64_tr_b16 a[82:83], v15 offset:2048
  v_exp_f32 v65, v65
  v_mfma_f32_16x16x32_bf16 v[120:123], a[88:91], v[60:63], v[120:123]
  ds_read_b64_tr_b16 a[84:85], v12 offset:4096
  s_waitcnt lgkmcnt(5)
  v_mfma_f32_16x16x32_bf16 v[124:127], a[72:75], v[52:55], v[124:127]
  v_exp_f32 v66, v66
  v_mfma_f32_16x16x32_bf16 v[128:131], a[72:75], v[56:59], v[128:131]
  ds_read_b64_tr_b16 a[86:87], v12 offset:6144
  buffer_load_dwordx4 v18, s[20:23], s31 offen offset:3072 lds
  v_cvt_pk_bf16_f32 v40, v64, v65
  v_mfma_f32_16x16x32_bf16 v[132:135], a[72:75], v[60:63], v[132:135]
  ds_read_b64_tr_b16 a[88:89], v13 offset:4096
  s_waitcnt lgkmcnt(5)
  v_mfma_f32_16x16x32_bf16 v[136:139], a[76:79], v[52:55], v[136:139]
  v_exp_f32 v67, v67
  v_mfma_f32_16x16x32_bf16 v[140:143], a[76:79], v[56:59], v[140:143]
  ds_read_b64_tr_b16 a[90:91], v13 offset:6144
  s_add_u32 s31, s31, 12288
  s_cmp_eq_u32 s31, s33
  s_cselect_b32 s31, s34, s31
  v_mfma_f32_16x16x32_bf16 v[144:147], a[76:79], v[60:63], v[144:147]
  ds_read_b64_tr_b16 a[72:73], v14 offset:4096
  s_waitcnt lgkmcnt(5)
  v_mfma_f32_16x16x32_bf16 v[148:151], a[80:83], v[52:55], v[148:151]
  v_exp_f32 v68, v68
  v_mfma_f32_16x16x32_bf16 v[152:155], a[80:83], v[56:59], v[152:155]
  ds_read_b64_tr_b16 a[74:75], v14 offset:6144
  v_cvt_pk_bf16_f32 v41, v66, v67
  v_mfma_f32_16x16x32_bf16 v[156:159], a[80:83], v[60:63], v[156:159]
  ds_read_b64_tr_b16 a[76:77], v15 offset:4096
  s_waitcnt lgkmcnt(5)
  v_mfma_f32_16x16x32_bf16 v[160:163], a[84:87], v[52:55], v[160:163]
  v_exp_f32 v69, v69
  v_mfma_f32_16x16x32_bf16 v[164:167], a[84:87], v[56:59], v[164:167]
  ds_read_b64_tr_b16 a[78:79], v15 offset:6144
  s_add_u32 m0, s30, 0
  s_nop 0
  buffer_load_dwordx4 v16, s[20:23], s31 offen offset:0 lds
  v_mfma_f32_16x16x32_bf16 v[168:171], a[84:87], v[60:63], v[168:171]
  ds_read_b64_tr_b16 a[80:81], v12 offset:8192
  s_waitcnt lgkmcnt(5)
  v_mfma_f32_16x16x32_bf16 v[172:175], a[88:91], v[52:55], v[172:175]
  v_exp_f32 v70, v70
  v_mfma_f32_16x16x32_bf16 v[176:179], a[88:91], v[56:59], v[176:179]
  ds_read_b64_tr_b16 a[82:83], v12 offset:10240
  v_cvt_pk_bf16_f32 v44, v68, v69
  v_mfma_f32_16x16x32_bf16 v[180:183], a[88:91], v[60:63], v[180:183]
  ds_read_b64_tr_b16 a[84:85], v13 offset:8192
  s_waitcnt lgkmcnt(5)
  v_mfma_f32_16x16x32_bf16 v[184:187], a[72:75], v[52:55], v[184:187]
  v_exp_f32 v71, v71
  v_mfma_f32_16x16x32_bf16 v[188:191], a[72:75], v[56:59], v[188:191]
  ds_read_b64_tr_b16 a[86:87], v13 offset:10240
  buffer_load_dwordx4 v16, s[20:23], s31 offen offset:1024 lds
  v_mfma_f32_16x16x32_bf16 v[192:195], a[72:75], v[60:63], v[192:195]
  ds_read_b64_tr_b16 a[88:89], v14 offset:8192
  s_waitcnt lgkmcnt(5)
  v_mfma_f32_16x16x32_bf16 v[196:199], a[76:79], v[52:55], v[196:199]
  v_exp_f32 v72, v72
  v_mfma_f32_16x16x32_bf16 v[200:203], a[76:79], v[56:59], v[200:203]
  ds_read_b64_tr_b16 a[90:91], v14 offset:10240
  v_cvt_pk_bf16_f32 v45, v70, v71
  v_mfma_f32_16x16x32_bf16 v[204:207], a[76:79], v[60:63], v[204:207]
  ds_read_b64_tr_b16 a[72:73], v15 offset:8192
  s_waitcnt lgkmcnt(5)
  v_mfma_f32_16x16x32_bf16 v[208:211], a[80:83], v[52:55], v[208:211]
  v_exp_f32 v73, v73
  v_mfma_f32_16x16x32_bf16 v[212:215], a[80:83], v[56:59], v[212:215]
  ds_read_b64_tr_b16 a[74:75], v15 offset:10240
  buffer_load_dwordx4 v16, s[20:23], s31 offen offset:2048 lds
  v_mfma_f32_16x16x32_bf16 v[216:219], a[80:83], v[60:63], v[216:219]
  s_waitcnt lgkmcnt(4)
  v_mfma_f32_16x16x32_bf16 v[220:223], a[84:87], v[52:55], v[220:223]
  v_exp_f32 v74, v74
  v_mfma_f32_16x16x32_bf16 v[224:227], a[84:87], v[56:59], v[224:227]
  v_cvt_pk_bf16_f32 v48, v72, v73
  v_mfma_f32_16x16x32_bf16 v[228:231], a[84:87], v[60:63], v[228:231]
  s_waitcnt vmcnt(11)
  ds_read_b128 a[76:79], v10 offset:24576
  s_waitcnt lgkmcnt(3)
  v_mfma_f32_16x16x32_bf16 v[232:235], a[88:91], v[52:55], v[232:235]
  v_exp_f32 v75, v75
  v_mfma_f32_16x16x32_bf16 v[236:239], a[88:91], v[56:59], v[236:239]
  buffer_load_dwordx4 v16, s[20:23], s31 offen offset:3072 lds
  v_mfma_f32_16x16x32_bf16 v[240:243], a[88:91], v[60:63], v[240:243]
  ds_read_b128 a[80:83], v10 offset:26624
  s_waitcnt lgkmcnt(2)
  v_mfma_f32_16x16x32_bf16 v[244:247], a[72:75], v[52:55], v[244:247]
  v_exp_f32 v76, v76
  v_mfma_f32_16x16x32_bf16 v[248:251], a[72:75], v[56:59], v[248:251]
  v_cvt_pk_bf16_f32 v49, v74, v75
  v_mfma_f32_16x16x32_bf16 v[252:255], a[72:75], v[60:63], v[252:255]
  ds_read_b128 a[84:87], v11 offset:24576
  v_mfma_f32_16x16x32_bf16 a[104:107], a[116:119], v[52:55], a[104:107]
  v_exp_f32 v77, v77
  v_mfma_f32_16x16x32_bf16 a[108:111], a[116:119], v[56:59], a[108:111]
  s_add_u32 m0, s30, 4096
  s_nop 0
  buffer_load_dwordx4 v17, s[20:23], s31 offen offset:0 lds
  v_mfma_f32_16x16x32_bf16 a[112:115], a[116:119], v[60:63], a[112:115]
  ds_read_b128 a[88:91], v11 offset:26624
  s_waitcnt lgkmcnt(3)
  v_mfma_f32_16x16x32_bf16 v[88:91], a[76:79], a[0:3], v[28:31]
  v_exp_f32 v78, v78
  v_mfma_f32_16x16x32_bf16 v[92:95], a[76:79], a[24:27], v[32:35]
  v_cvt_pk_bf16_f32 v42, v76, v77
  v_mfma_f32_16x16x32_bf16 v[96:99], a[76:79], a[48:51], v[36:39]
  s_waitcnt vmcnt(9)
  ds_read_b128 a[72:75], v10 offset:28672
  s_waitcnt lgkmcnt(3)
  v_mfma_f32_16x16x32_bf16 v[100:103], a[80:83], a[0:3], v[28:31]
  v_exp_f32 v79, v79
  v_mfma_f32_16x16x32_bf16 v[104:107], a[80:83], a[24:27], v[32:35]
  buffer_load_dwordx4 v17, s[20:23], s31 offen offset:1024 lds
  v_mfma_f32_16x16x32_bf16 v[108:111], a[80:83], a[48:51], v[36:39]
  ds_read_b128 a[76:79], v10 offset:30720
  s_waitcnt lgkmcnt(3)
  v_mfma_f32_16x16x32_bf16 v[88:91], a[84:87], a[4:7], v[88:91]
  v_exp_f32 v80, v80
  v_mfma_f32_16x16x32_bf16 v[92:95], a[84:87], a[28:31], v[92:95]
  v_cvt_pk_bf16_f32 v43, v78, v79
  v_mfma_f32_16x16x32_bf16 v[96:99], a[84:87], a[52:55], v[96:99]
  ds_read_b128 a[80:83], v11 offset:28672
  s_waitcnt lgkmcnt(3)
  v_mfma_f32_16x16x32_bf16 v[100:103], a[88:91], a[4:7], v[100:103]
  v_exp_f32 v81, v81
  v_mfma_f32_16x16x32_bf16 v[104:107], a[88:91], a[28:31], v[104:107]
  buffer_load_dwordx4 v17, s[20:23], s31 offen offset:2048 lds
  v_mfma_f32_16x16x32_bf16 v[108:111], a[88:91], a[52:55], v[108:111]
  ds_read_b128 a[84:87], v11 offset:30720
  s_waitcnt lgkmcnt(3)
  v_mfma_f32_16x16x32_bf16 v[88:91], a[72:75], a[8:11], v[88:91]
  v_exp_f32 v82, v82
  v_mfma_f32_16x16x32_bf16 v[92:95], a[72:75], a[32:35], v[92:95]
  v_cvt_pk_bf16_f32 v46, v80, v81
  v_mfma_f32_16x16x32_bf16 v[96:99], a[72:75], a[56:59], v[96:99]
  s_waitcnt vmcnt(7)
  ds_read_b128 a[88:91], v10 offset:32768
  s_waitcnt lgkmcnt(3)
  v_mfma_f32_16x16x32_bf16 v[100:103], a[76:79], a[8:11], v[100:103]
  v_exp_f32 v83, v83
  v_mfma_f32_16x16x32_bf16 v[104:107], a[76:79], a[32:35], v[104:107]
  buffer_load_dwordx4 v17, s[20:23], s31 offen offset:3072 lds
  v_mfma_f32_16x16x32_bf16 v[108:111], a[76:79], a[56:59], v[108:111]
  ds_read_b128 a[72:75], v10 offset:34816
  s_waitcnt lgkmcnt(3)
  v_mfma_f32_16x16x32_bf16 v[88:91], a[80:83], a[12:15], v[88:91]
  v_exp_f32 v84, v84
  v_mfma_f32_16x16x32_bf16 v[92:95], a[80:83], a[36:39], v[92:95]
  v_cvt_pk_bf16_f32 v47, v82, v83
  v_mfma_f32_16x16x32_bf16 v[96:99], a[80:83], a[60:63], v[96:99]
  ds_read_b128 a[76:79], v11 offset:32768
  s_waitcnt lgkmcnt(3)
  v_mfma_f32_16x16x32_bf16 v[100:103], a[84:87], a[12:15], v[100:103]
  v_exp_f32 v85, v85
  v_mfma_f32_16x16x32_bf16 v[104:107], a[84:87], a[36:39], v[104:107]
  s_add_u32 m0, s30, 8192
  s_nop 0
  buffer_load_dwordx4 v18, s[20:23], s31 offen offset:0 lds
  v_mfma_f32_16x16x32_bf16 v[108:111], a[84:87], a[60:63], v[108:111]
  ds_read_b128 a[80:83], v11 offset:34816
  s_waitcnt lgkmcnt(3)
  v_mfma_f32_16x16x32_bf16 v[88:91], a[88:91], a[16:19], v[88:91]
  v_exp_f32 v86, v86
  v_mfma_f32_16x16x32_bf16 v[92:95], a[88:91], a[40:43], v[92:95]
  v_cvt_pk_bf16_f32 v50, v84, v85
  v_mfma_f32_16x16x32_bf16 v[96:99], a[88:91], a[64:67], v[96:99]
  ds_read_b64_tr_b16 a[84:85], v12 offset:12288
  s_waitcnt lgkmcnt(3)
  v_mfma_f32_16x16x32_bf16 v[100:103], a[72:75], a[16:19], v[100:103]
  v_exp_f32 v87, v87
  v_mfma_f32_16x16x32_bf16 v[104:107], a[72:75], a[40:43], v[104:107]
  ds_read_b64_tr_b16 a[86:87], v12 offset:14336
  buffer_load_dwordx4 v18, s[20:23], s31 offen offset:1024 lds
  v_mfma_f32_16x16x32_bf16 v[108:111], a[72:75], a[64:67], v[108:111]
  ds_read_b64_tr_b16 a[88:89], v13 offset:12288
  s_waitcnt lgkmcnt(4)
  v_mfma_f32_16x16x32_bf16 v[88:91], a[76:79], a[20:23], v[88:91]
  v_cvt_pk_bf16_f32 v51, v86, v87
  v_mfma_f32_16x16x32_bf16 v[92:95], a[76:79], a[44:47], v[92:95]
  ds_read_b64_tr_b16 a[90:91], v13 offset:14336
  v_mfma_f32_16x16x32_bf16 v[96:99], a[76:79], a[68:71], v[96:99]
  ds_read_b64_tr_b16 a[72:73], v14 offset:12288
  s_waitcnt lgkmcnt(5)
  v_mfma_f32_16x16x32_bf16 v[100:103], a[80:83], a[20:23], v[100:103]
  v_mfma_f32_16x16x32_bf16 v[104:107], a[80:83], a[44:47], v[104:107]
  ds_read_b64_tr_b16 a[74:75], v14 offset:14336
  buffer_load_dwordx4 v18, s[20:23], s31 offen offset:2048 lds
  v_mfma_f32_16x16x32_bf16 v[108:111], a[80:83], a[68:71], v[108:111]
  ds_read_b64_tr_b16 a[76:77], v15 offset:12288
  s_waitcnt lgkmcnt(5)
  v_mfma_f32_16x16x32_bf16 v[112:115], a[84:87], v[40:43], v[112:115]
  v_exp_f32 v88, v88
  v_mfma_f32_16x16x32_bf16 v[116:119], a[84:87], v[44:47], v[116:119]
  ds_read_b64_tr_b16 a[78:79], v15 offset:14336
  v_exp_f32 v89, v89
  v_mfma_f32_16x16x32_bf16 v[120:123], a[84:87], v[48:51], v[120:123]
  ds_read_b64_tr_b16 a[80:81], v12 offset:16384
  s_waitcnt lgkmcnt(5)
  v_mfma_f32_16x16x32_bf16 v[124:127], a[88:91], v[40:43], v[124:127]
  v_exp_f32 v90, v90
  v_mfma_f32_16x16x32_bf16 v[128:131], a[88:91], v[44:47], v[128:131]
  ds_read_b64_tr_b16 a[82:83], v12 offset:18432
  buffer_load_dwordx4 v18, s[20:23], s31 offen offset:3072 lds
  v_cvt_pk_bf16_f32 v52, v88, v89
  v_mfma_f32_16x16x32_bf16 v[132:135], a[88:91], v[48:51], v[132:135]
  ds_read_b64_tr_b16 a[84:85], v13 offset:16384
  s_waitcnt lgkmcnt(5)
  v_mfma_f32_16x16x32_bf16 v[136:139], a[72:75], v[40:43], v[136:139]
  v_exp_f32 v91, v91
  v_mfma_f32_16x16x32_bf16 v[140:143], a[72:75], v[44:47], v[140:143]
  ds_read_b64_tr_b16 a[86:87], v13 offset:18432
  s_add_u32 s31, s31, 12288
  s_cmp_eq_u32 s31, s33
  s_cselect_b32 s31, s34, s31
  v_mfma_f32_16x16x32_bf16 v[144:147], a[72:75], v[48:51], v[144:147]
  ds_read_b64_tr_b16 a[88:89], v14 offset:16384
  s_waitcnt lgkmcnt(5)
  v_mfma_f32_16x16x32_bf16 v[148:151], a[76:79], v[40:43], v[148:151]
  v_exp_f32 v92, v92
  v_mfma_f32_16x16x32_bf16 v[152:155], a[76:79], v[44:47], v[152:155]
  ds_read_b64_tr_b16 a[90:91], v14 offset:18432
  v_cvt_pk_bf16_f32 v53, v90, v91
  v_mfma_f32_16x16x32_bf16 v[156:159], a[76:79], v[48:51], v[156:159]
  ds_read_b64_tr_b16 a[72:73], v15 offset:16384
  s_waitcnt lgkmcnt(5)
  v_mfma_f32_16x16x32_bf16 v[160:163], a[80:83], v[40:43], v[160:163]
  v_exp_f32 v93, v93
  v_mfma_f32_16x16x32_bf16 v[164:167], a[80:83], v[44:47], v[164:167]
  ds_read_b64_tr_b16 a[74:75], v15 offset:18432
  s_add_u32 m0, s30, 12288
  s_nop 0
  buffer_load_dwordx4 v16, s[20:23], s31 offen offset:0 lds
  v_mfma_f32_16x16x32_bf16 v[168:171], a[80:83], v[48:51], v[168:171]
  ds_read_b64_tr_b16 a[76:77], v12 offset:20480
  s_waitcnt lgkmcnt(5)
  v_mfma_f32_16x16x32_bf16 v[172:175], a[84:87], v[40:43], v[172:175]
  v_exp_f32 v94, v94
  v_mfma_f32_16x16x32_bf16 v[176:179], a[84:87], v[44:47], v[176:179]
  ds_read_b64_tr_b16 a[78:79], v12 offset:22528
  v_cvt_pk_bf16_f32 v56, v92, v93
  v_mfma_f32_16x16x32_bf16 v[180:183], a[84:87], v[48:51], v[180:183]
  ds_read_b64_tr_b16 a[80:81], v13 offset:20480
  s_waitcnt lgkmcnt(5)
  v_mfma_f32_16x16x32_bf16 v[184:187], a[88:91], v[40:43], v[184:187]
  v_exp_f32 v95, v95
  v_mfma_f32_16x16x32_bf16 v[188:191], a[88:91], v[44:47], v[188:191]
  ds_read_b64_tr_b16 a[82:83], v13 offset:22528
  buffer_load_dwordx4 v16, s[20:23], s31 offen offset:1024 lds
  v_mfma_f32_16x16x32_bf16 v[192:195], a[88:91], v[48:51], v[192:195]
  ds_read_b64_tr_b16 a[84:85], v14 offset:20480
  s_waitcnt lgkmcnt(5)
  v_mfma_f32_16x16x32_bf16 v[196:199], a[72:75], v[40:43], v[196:199]
  v_exp_f32 v96, v96
  v_mfma_f32_16x16x32_bf16 v[200:203], a[72:75], v[44:47], v[200:203]
  ds_read_b64_tr_b16 a[86:87], v14 offset:22528
  v_cvt_pk_bf16_f32 v57, v94, v95
  v_mfma_f32_16x16x32_bf16 v[204:207], a[72:75], v[48:51], v[204:207]
  ds_read_b64_tr_b16 a[88:89], v15 offset:20480
  s_waitcnt lgkmcnt(5)
  v_mfma_f32_16x16x32_bf16 v[208:211], a[76:79], v[40:43], v[208:211]
  v_exp_f32 v97, v97
  v_mfma_f32_16x16x32_bf16 v[212:215], a[76:79], v[44:47], v[212:215]
  ds_read_b64_tr_b16 a[90:91], v15 offset:22528
  buffer_load_dwordx4 v16, s[20:23], s31 offen offset:2048 lds
  v_mfma_f32_16x16x32_bf16 v[216:219], a[76:79], v[48:51], v[216:219]
  s_waitcnt lgkmcnt(4)
  v_mfma_f32_16x16x32_bf16 v[220:223], a[80:83], v[40:43], v[220:223]
  v_exp_f32 v98, v98
  v_mfma_f32_16x16x32_bf16 v[224:227], a[80:83], v[44:47], v[224:227]
  v_cvt_pk_bf16_f32 v60, v96, v97
  v_mfma_f32_16x16x32_bf16 v[228:231], a[80:83], v[48:51], v[228:231]
  s_waitcnt vmcnt(11)
  ds_read_b128 a[72:75], v10 offset:0
  s_waitcnt lgkmcnt(3)
  v_mfma_f32_16x16x32_bf16 v[232:235], a[84:87], v[40:43], v[232:235]
  v_exp_f32 v99, v99
  v_mfma_f32_16x16x32_bf16 v[236:239], a[84:87], v[44:47], v[236:239]
  buffer_load_dwordx4 v16, s[20:23], s31 offen offset:3072 lds
  v_mfma_f32_16x16x32_bf16 v[240:243], a[84:87], v[48:51], v[240:243]
  ds_read_b128 a[76:79], v10 offset:2048
  s_waitcnt lgkmcnt(2)
  v_mfma_f32_16x16x32_bf16 v[244:247], a[88:91], v[40:43], v[244:247]
  v_exp_f32 v100, v100
  v_mfma_f32_16x16x32_bf16 v[248:251], a[88:91], v[44:47], v[248:251]
  v_cvt_pk_bf16_f32 v61, v98, v99
  v_mfma_f32_16x16x32_bf16 v[252:255], a[88:91], v[48:51], v[252:255]
  ds_read_b128 a[80:83], v11 offset:0
  v_mfma_f32_16x16x32_bf16 a[104:107], a[116:119], v[40:43], a[104:107]
  v_exp_f32 v101, v101
  v_mfma_f32_16x16x32_bf16 a[108:111], a[116:119], v[44:47], a[108:111]
  s_add_u32 m0, s30, 16384
  s_nop 0
  buffer_load_dwordx4 v17, s[20:23], s31 offen offset:0 lds
  v_mfma_f32_16x16x32_bf16 a[112:115], a[116:119], v[48:51], a[112:115]
  ds_read_b128 a[84:87], v11 offset:2048
  s_waitcnt lgkmcnt(3)
  v_mfma_f32_16x16x32_bf16 v[64:67], a[72:75], a[0:3], v[28:31]
  v_exp_f32 v102, v102
  v_mfma_f32_16x16x32_bf16 v[68:71], a[72:75], a[24:27], v[32:35]
  v_cvt_pk_bf16_f32 v54, v100, v101
  v_mfma_f32_16x16x32_bf16 v[72:75], a[72:75], a[48:51], v[36:39]
  s_waitcnt vmcnt(9)
  ds_read_b128 a[88:91], v10 offset:4096
  s_waitcnt lgkmcnt(3)
  v_mfma_f32_16x16x32_bf16 v[76:79], a[76:79], a[0:3], v[28:31]
  v_exp_f32 v103, v103
  v_mfma_f32_16x16x32_bf16 v[80:83], a[76:79], a[24:27], v[32:35]
  buffer_load_dwordx4 v17, s[20:23], s31 offen offset:1024 lds
  v_mfma_f32_16x16x32_bf16 v[84:87], a[76:79], a[48:51], v[36:39]
  ds_read_b128 a[72:75], v10 offset:6144
  s_waitcnt lgkmcnt(3)
  v_mfma_f32_16x16x32_bf16 v[64:67], a[80:83], a[4:7], v[64:67]
  v_exp_f32 v104, v104
  v_mfma_f32_16x16x32_bf16 v[68:71], a[80:83], a[28:31], v[68:71]
  v_cvt_pk_bf16_f32 v55, v102, v103
  v_mfma_f32_16x16x32_bf16 v[72:75], a[80:83], a[52:55], v[72:75]
  ds_read_b128 a[76:79], v11 offset:4096
  s_waitcnt lgkmcnt(3)
  v_mfma_f32_16x16x32_bf16 v[76:79], a[84:87], a[4:7], v[76:79]
  v_exp_f32 v105, v105
  v_mfma_f32_16x16x32_bf16 v[80:83], a[84:87], a[28:31], v[80:83]
  buffer_load_dwordx4 v17, s[20:23], s31 offen offset:2048 lds
  v_mfma_f32_16x16x32_bf16 v[84:87], a[84:87], a[52:55], v[84:87]
  ds_read_b128 a[80:83], v11 offset:6144
  s_waitcnt lgkmcnt(3)
  v_mfma_f32_16x16x32_bf16 v[64:67], a[88:91], a[8:11], v[64:67]
  v_exp_f32 v106, v106
  v_mfma_f32_16x16x32_bf16 v[68:71], a[88:91], a[32:35], v[68:71]
  v_cvt_pk_bf16_f32 v58, v104, v105
  v_mfma_f32_16x16x32_bf16 v[72:75], a[88:91], a[56:59], v[72:75]
  s_waitcnt vmcnt(7)
  ds_read_b128 a[84:87], v10 offset:8192
  s_waitcnt lgkmcnt(3)
  v_mfma_f32_16x16x32_bf16 v[76:79], a[72:75], a[8:11], v[76:79]
  v_exp_f32 v107, v107
  v_mfma_f32_16x16x32_bf16 v[80:83], a[72:75], a[32:35], v[80:83]
  buffer_load_dwordx4 v17, s[20:23], s31 offen offset:3072 lds
  v_mfma_f32_16x16x32_bf16 v[84:87], a[72:75], a[56:59], v[84:87]
  ds_read_b128 a[88:91], v10 offset:10240
  s_waitcnt lgkmcnt(3)
  v_mfma_f32_16x16x32_bf16 v[64:67], a[76:79], a[12:15], v[64:67]
  v_exp_f32 v108, v108
  v_mfma_f32_16x16x32_bf16 v[68:71], a[76:79], a[36:39], v[68:71]
  v_cvt_pk_bf16_f32 v59, v106, v107
  v_mfma_f32_16x16x32_bf16 v[72:75], a[76:79], a[60:63], v[72:75]
  ds_read_b128 a[72:75], v11 offset:8192
  s_waitcnt lgkmcnt(3)
  v_mfma_f32_16x16x32_bf16 v[76:79], a[80:83], a[12:15], v[76:79]
  v_exp_f32 v109, v109
  v_mfma_f32_16x16x32_bf16 v[80:83], a[80:83], a[36:39], v[80:83]
  s_add_u32 m0, s30, 20480
  s_nop 0
  buffer_load_dwordx4 v18, s[20:23], s31 offen offset:0 lds
  v_mfma_f32_16x16x32_bf16 v[84:87], a[80:83], a[60:63], v[84:87]
  ds_read_b128 a[76:79], v11 offset:10240
  s_waitcnt lgkmcnt(3)
  v_mfma_f32_16x16x32_bf16 v[64:67], a[84:87], a[16:19], v[64:67]
  v_exp_f32 v110, v110
  v_mfma_f32_16x16x32_bf16 v[68:71], a[84:87], a[40:43], v[68:71]
  v_cvt_pk_bf16_f32 v62, v108, v109
  v_mfma_f32_16x16x32_bf16 v[72:75], a[84:87], a[64:67], v[72:75]
  ds_read_b64_tr_b16 a[80:81], v12 offset:24576
  s_waitcnt lgkmcnt(3)
  v_mfma_f32_16x16x32_bf16 v[76:79], a[88:91], a[16:19], v[76:79]
  v_exp_f32 v111, v111
  v_mfma_f32_16x16x32_bf16 v[80:83], a[88:91], a[40:43], v[80:83]
  ds_read_b64_tr_b16 a[82:83], v12 offset:26624
  buffer_load_dwordx4 v18, s[20:23], s31 offen offset:1024 lds
  v_mfma_f32_16x16x32_bf16 v[84:87], a[88:91], a[64:67], v[84:87]
  ds_read_b64_tr_b16 a[84:85], v13 offset:24576
  s_waitcnt lgkmcnt(4)
  v_mfma_f32_16x16x32_bf16 v[64:67], a[72:75], a[20:23], v[64:67]
  v_cvt_pk_bf16_f32 v63, v110, v111
  v_mfma_f32_16x16x32_bf16 v[68:71], a[72:75], a[44:47], v[68:71]
  ds_read_b64_tr_b16 a[86:87], v13 offset:26624
  v_mfma_f32_16x16x32_bf16 v[72:75], a[72:75], a[68:71], v[72:75]
  ds_read_b64_tr_b16 a[88:89], v14 offset:24576
  s_waitcnt lgkmcnt(5)
  v_mfma_f32_16x16x32_bf16 v[76:79], a[76:79], a[20:23], v[76:79]
  v_mfma_f32_16x16x32_bf16 v[80:83], a[76:79], a[44:47], v[80:83]
  ds_read_b64_tr_b16 a[90:91], v14 offset:26624
  buffer_load_dwordx4 v18, s[20:23], s31 offen offset:2048 lds
  v_mfma_f32_16x16x32_bf16 v[84:87], a[76:79], a[68:71], v[84:87]
  ds_read_b64_tr_b16 a[72:73], v15 offset:24576
  s_waitcnt lgkmcnt(5)
  v_mfma_f32_16x16x32_bf16 v[112:115], a[80:83], v[52:55], v[112:115]
  v_exp_f32 v64, v64
  v_mfma_f32_16x16x32_bf16 v[116:119], a[80:83], v[56:59], v[116:119]
  ds_read_b64_tr_b16 a[74:75], v15 offset:26624
  v_exp_f32 v65, v65
  v_mfma_f32_16x16x32_bf16 v[120:123], a[80:83], v[60:63], v[120:123]
  ds_read_b64_tr_b16 a[76:77], v12 offset:28672
  s_waitcnt lgkmcnt(5)
  v_mfma_f32_16x16x32_bf16 v[124:127], a[84:87], v[52:55], v[124:127]
  v_exp_f32 v66, v66
  v_mfma_f32_16x16x32_bf16 v[128:131], a[84:87], v[56:59], v[128:131]
  ds_read_b64_tr_b16 a[78:79], v12 offset:30720
  buffer_load_dwordx4 v18, s[20:23], s31 offen offset:3072 lds
  v_cvt_pk_bf16_f32 v40, v64, v65
  v_mfma_f32_16x16x32_bf16 v[132:135], a[84:87], v[60:63], v[132:135]
  ds_read_b64_tr_b16 a[80:81], v13 offset:28672
  s_waitcnt lgkmcnt(5)
  v_mfma_f32_16x16x32_bf16 v[136:139], a[88:91], v[52:55], v[136:139]
  v_exp_f32 v67, v67
  v_mfma_f32_16x16x32_bf16 v[140:143], a[88:91], v[56:59], v[140:143]
  ds_read_b64_tr_b16 a[82:83], v13 offset:30720
  s_add_u32 s31, s31, 12288
  s_cmp_eq_u32 s31, s33
  s_cselect_b32 s31, s34, s31
  v_mfma_f32_16x16x32_bf16 v[144:147], a[88:91], v[60:63], v[144:147]
  ds_read_b64_tr_b16 a[84:85], v14 offset:28672
  s_waitcnt lgkmcnt(5)
  v_mfma_f32_16x16x32_bf16 v[148:151], a[72:75], v[52:55], v[148:151]
  v_exp_f32 v68, v68
  v_mfma_f32_16x16x32_bf16 v[152:155], a[72:75], v[56:59], v[152:155]
  ds_read_b64_tr_b16 a[86:87], v14 offset:30720
  v_cvt_pk_bf16_f32 v41, v66, v67
  v_mfma_f32_16x16x32_bf16 v[156:159], a[72:75], v[60:63], v[156:159]
  ds_read_b64_tr_b16 a[88:89], v15 offset:28672
  s_waitcnt lgkmcnt(5)
  v_mfma_f32_16x16x32_bf16 v[160:163], a[76:79], v[52:55], v[160:163]
  v_exp_f32 v69, v69
  v_mfma_f32_16x16x32_bf16 v[164:167], a[76:79], v[56:59], v[164:167]
  ds_read_b64_tr_b16 a[90:91], v15 offset:30720
  s_add_u32 m0, s30, 24576
  s_nop 0
  buffer_load_dwordx4 v16, s[20:23], s31 offen offset:0 lds
  v_mfma_f32_16x16x32_bf16 v[168:171], a[76:79], v[60:63], v[168:171]
  ds_read_b64_tr_b16 a[72:73], v12 offset:32768
  s_waitcnt lgkmcnt(5)
  v_mfma_f32_16x16x32_bf16 v[172:175], a[80:83], v[52:55], v[172:175]
  v_exp_f32 v70, v70
  v_mfma_f32_16x16x32_bf16 v[176:179], a[80:83], v[56:59], v[176:179]
  ds_read_b64_tr_b16 a[74:75], v12 offset:34816
  v_cvt_pk_bf16_f32 v44, v68, v69
  v_mfma_f32_16x16x32_bf16 v[180:183], a[80:83], v[60:63], v[180:183]
  ds_read_b64_tr_b16 a[76:77], v13 offset:32768
  s_waitcnt lgkmcnt(5)
  v_mfma_f32_16x16x32_bf16 v[184:187], a[84:87], v[52:55], v[184:187]
  v_exp_f32 v71, v71
  v_mfma_f32_16x16x32_bf16 v[188:191], a[84:87], v[56:59], v[188:191]
  ds_read_b64_tr_b16 a[78:79], v13 offset:34816
  buffer_load_dwordx4 v16, s[20:23], s31 offen offset:1024 lds
  v_mfma_f32_16x16x32_bf16 v[192:195], a[84:87], v[60:63], v[192:195]
  ds_read_b64_tr_b16 a[80:81], v14 offset:32768
  s_waitcnt lgkmcnt(5)
  v_mfma_f32_16x16x32_bf16 v[196:199], a[88:91], v[52:55], v[196:199]
  v_exp_f32 v72, v72
  v_mfma_f32_16x16x32_bf16 v[200:203], a[88:91], v[56:59], v[200:203]
  ds_read_b64_tr_b16 a[82:83], v14 offset:34816
  v_cvt_pk_bf16_f32 v45, v70, v71
  v_mfma_f32_16x16x32_bf16 v[204:207], a[88:91], v[60:63], v[204:207]
  ds_read_b64_tr_b16 a[84:85], v15 offset:32768
  s_waitcnt lgkmcnt(5)
  v_mfma_f32_16x16x32_bf16 v[208:211], a[72:75], v[52:55], v[208:211]
  v_exp_f32 v73, v73
  v_mfma_f32_16x16x32_bf16 v[212:215], a[72:75], v[56:59], v[212:215]
  ds_read_b64_tr_b16 a[86:87], v15 offset:34816
  buffer_load_dwordx4 v16, s[20:23], s31 offen offset:2048 lds
  v_mfma_f32_16x16x32_bf16 v[216:219], a[72:75], v[60:63], v[216:219]
  s_waitcnt lgkmcnt(4)
  v_mfma_f32_16x16x32_bf16 v[220:223], a[76:79], v[52:55], v[220:223]
  v_exp_f32 v74, v74
  v_mfma_f32_16x16x32_bf16 v[224:227], a[76:79], v[56:59], v[224:227]
  v_cvt_pk_bf16_f32 v48, v72, v73
  v_mfma_f32_16x16x32_bf16 v[228:231], a[76:79], v[60:63], v[228:231]
  s_waitcnt vmcnt(11)
  ds_read_b128 a[88:91], v10 offset:12288
  s_waitcnt lgkmcnt(3)
  v_mfma_f32_16x16x32_bf16 v[232:235], a[80:83], v[52:55], v[232:235]
  v_exp_f32 v75, v75
  v_mfma_f32_16x16x32_bf16 v[236:239], a[80:83], v[56:59], v[236:239]
  buffer_load_dwordx4 v16, s[20:23], s31 offen offset:3072 lds
  v_mfma_f32_16x16x32_bf16 v[240:243], a[80:83], v[60:63], v[240:243]
  ds_read_b128 a[72:75], v10 offset:14336
  s_waitcnt lgkmcnt(2)
  v_mfma_f32_16x16x32_bf16 v[244:247], a[84:87], v[52:55], v[244:247]
  v_exp_f32 v76, v76
  v_mfma_f32_16x16x32_bf16 v[248:251], a[84:87], v[56:59], v[248:251]
  v_cvt_pk_bf16_f32 v49, v74, v75
  v_mfma_f32_16x16x32_bf16 v[252:255], a[84:87], v[60:63], v[252:255]
  ds_read_b128 a[76:79], v11 offset:12288
  v_mfma_f32_16x16x32_bf16 a[104:107], a[116:119], v[52:55], a[104:107]
  v_exp_f32 v77, v77
  v_mfma_f32_16x16x32_bf16 a[108:111], a[116:119], v[56:59], a[108:111]
  s_add_u32 m0, s30, 28672
  s_nop 0
  buffer_load_dwordx4 v17, s[20:23], s31 offen offset:0 lds
  v_mfma_f32_16x16x32_bf16 a[112:115], a[116:119], v[60:63], a[112:115]
  ds_read_b128 a[80:83], v11 offset:14336
  s_waitcnt lgkmcnt(3)
  v_mfma_f32_16x16x32_bf16 v[88:91], a[88:91], a[0:3], v[28:31]
  v_exp_f32 v78, v78
  v_mfma_f32_16x16x32_bf16 v[92:95], a[88:91], a[24:27], v[32:35]
  v_cvt_pk_bf16_f32 v42, v76, v77
  v_mfma_f32_16x16x32_bf16 v[96:99], a[88:91], a[48:51], v[36:39]
  s_waitcnt vmcnt(9)
  ds_read_b128 a[84:87], v10 offset:16384
  s_waitcnt lgkmcnt(3)
  v_mfma_f32_16x16x32_bf16 v[100:103], a[72:75], a[0:3], v[28:31]
  v_exp_f32 v79, v79
  v_mfma_f32_16x16x32_bf16 v[104:107], a[72:75], a[24:27], v[32:35]
  buffer_load_dwordx4 v17, s[20:23], s31 offen offset:1024 lds
  v_mfma_f32_16x16x32_bf16 v[108:111], a[72:75], a[48:51], v[36:39]
  ds_read_b128 a[88:91], v10 offset:18432
  s_waitcnt lgkmcnt(3)
  v_mfma_f32_16x16x32_bf16 v[88:91], a[76:79], a[4:7], v[88:91]
  v_exp_f32 v80, v80
  v_mfma_f32_16x16x32_bf16 v[92:95], a[76:79], a[28:31], v[92:95]
  v_cvt_pk_bf16_f32 v43, v78, v79
  v_mfma_f32_16x16x32_bf16 v[96:99], a[76:79], a[52:55], v[96:99]
  ds_read_b128 a[72:75], v11 offset:16384
  s_waitcnt lgkmcnt(3)
  v_mfma_f32_16x16x32_bf16 v[100:103], a[80:83], a[4:7], v[100:103]
  v_exp_f32 v81, v81
  v_mfma_f32_16x16x32_bf16 v[104:107], a[80:83], a[28:31], v[104:107]
  buffer_load_dwordx4 v17, s[20:23], s31 offen offset:2048 lds
  v_mfma_f32_16x16x32_bf16 v[108:111], a[80:83], a[52:55], v[108:111]
  ds_read_b128 a[76:79], v11 offset:18432
  s_waitcnt lgkmcnt(3)
  v_mfma_f32_16x16x32_bf16 v[88:91], a[84:87], a[8:11], v[88:91]
  v_exp_f32 v82, v82
  v_mfma_f32_16x16x32_bf16 v[92:95], a[84:87], a[32:35], v[92:95]
  v_cvt_pk_bf16_f32 v46, v80, v81
  v_mfma_f32_16x16x32_bf16 v[96:99], a[84:87], a[56:59], v[96:99]
  s_waitcnt vmcnt(7)
  ds_read_b128 a[80:83], v10 offset:20480
  s_waitcnt lgkmcnt(3)
  v_mfma_f32_16x16x32_bf16 v[100:103], a[88:91], a[8:11], v[100:103]
  v_exp_f32 v83, v83
  v_mfma_f32_16x16x32_bf16 v[104:107], a[88:91], a[32:35], v[104:107]
  buffer_load_dwordx4 v17, s[20:23], s31 offen offset:3072 lds
  v_mfma_f32_16x16x32_bf16 v[108:111], a[88:91], a[56:59], v[108:111]
  ds_read_b128 a[84:87], v10 offset:22528
  s_waitcnt lgkmcnt(3)
  v_mfma_f32_16x16x32_bf16 v[88:91], a[72:75], a[12:15], v[88:91]
  v_exp_f32 v84, v84
  v_mfma_f32_16x16x32_bf16 v[92:95], a[72:75], a[36:39], v[92:95]
  v_cvt_pk_bf16_f32 v47, v82, v83
  v_mfma_f32_16x16x32_bf16 v[96:99], a[72:75], a[60:63], v[96:99]
  ds_read_b128 a[88:91], v11 offset:20480
  s_waitcnt lgkmcnt(3)
  v_mfma_f32_16x16x32_bf16 v[100:103], a[76:79], a[12:15], v[100:103]
  v_exp_f32 v85, v85
  v_mfma_f32_16x16x32_bf16 v[104:107], a[76:79], a[36:39], v[104:107]
  s_add_u32 m0, s30, 32768
  s_nop 0
  buffer_load_dwordx4 v18, s[20:23], s31 offen offset:0 lds
  v_mfma_f32_16x16x32_bf16 v[108:111], a[76:79], a[60:63], v[108:111]
  ds_read_b128 a[72:75], v11 offset:22528
  s_waitcnt lgkmcnt(3)
  v_mfma_f32_16x16x32_bf16 v[88:91], a[80:83], a[16:19], v[88:91]
  v_exp_f32 v86, v86
  v_mfma_f32_16x16x32_bf16 v[92:95], a[80:83], a[40:43], v[92:95]
  v_cvt_pk_bf16_f32 v50, v84, v85
  v_mfma_f32_16x16x32_bf16 v[96:99], a[80:83], a[64:67], v[96:99]
  ds_read_b64_tr_b16 a[76:77], v12 offset:0
  s_waitcnt lgkmcnt(3)
  v_mfma_f32_16x16x32_bf16 v[100:103], a[84:87], a[16:19], v[100:103]
  v_exp_f32 v87, v87
  v_mfma_f32_16x16x32_bf16 v[104:107], a[84:87], a[40:43], v[104:107]
  ds_read_b64_tr_b16 a[78:79], v12 offset:2048
  buffer_load_dwordx4 v18, s[20:23], s31 offen offset:1024 lds
  v_mfma_f32_16x16x32_bf16 v[108:111], a[84:87], a[64:67], v[108:111]
  ds_read_b64_tr_b16 a[80:81], v13 offset:0
  s_waitcnt lgkmcnt(4)
  v_mfma_f32_16x16x32_bf16 v[88:91], a[88:91], a[20:23], v[88:91]
  v_cvt_pk_bf16_f32 v51, v86, v87
  v_mfma_f32_16x16x32_bf16 v[92:95], a[88:91], a[44:47], v[92:95]
  ds_read_b64_tr_b16 a[82:83], v13 offset:2048
  v_mfma_f32_16x16x32_bf16 v[96:99], a[88:91], a[68:71], v[96:99]
  ds_read_b64_tr_b16 a[84:85], v14 offset:0
  s_waitcnt lgkmcnt(5)
  v_mfma_f32_16x16x32_bf16 v[100:103], a[72:75], a[20:23], v[100:103]
  v_mfma_f32_16x16x32_bf16 v[104:107], a[72:75], a[44:47], v[104:107]
  ds_read_b64_tr_b16 a[86:87], v14 offset:2048
  buffer_load_dwordx4 v18, s[20:23], s31 offen offset:2048 lds
  v_mfma_f32_16x16x32_bf16 v[108:111], a[72:75], a[68:71], v[108:111]
  ds_read_b64_tr_b16 a[88:89], v15 offset:0
  s_waitcnt lgkmcnt(5)
  v_mfma_f32_16x16x32_bf16 v[112:115], a[76:79], v[40:43], v[112:115]
  v_exp_f32 v88, v88
  v_mfma_f32_16x16x32_bf16 v[116:119], a[76:79], v[44:47], v[116:119]
  ds_read_b64_tr_b16 a[90:91], v15 offset:2048
  v_exp_f32 v89, v89
  v_mfma_f32_16x16x32_bf16 v[120:123], a[76:79], v[48:51], v[120:123]
  ds_read_b64_tr_b16 a[72:73], v12 offset:4096
  s_waitcnt lgkmcnt(5)
  v_mfma_f32_16x16x32_bf16 v[124:127], a[80:83], v[40:43], v[124:127]
  v_exp_f32 v90, v90
  v_mfma_f32_16x16x32_bf16 v[128:131], a[80:83], v[44:47], v[128:131]
  ds_read_b64_tr_b16 a[74:75], v12 offset:6144
  buffer_load_dwordx4 v18, s[20:23], s31 offen offset:3072 lds
  v_cvt_pk_bf16_f32 v52, v88, v89
  v_mfma_f32_16x16x32_bf16 v[132:135], a[80:83], v[48:51], v[132:135]
  ds_read_b64_tr_b16 a[76:77], v13 offset:4096
  s_waitcnt lgkmcnt(5)
  v_mfma_f32_16x16x32_bf16 v[136:139], a[84:87], v[40:43], v[136:139]
  v_exp_f32 v91, v91
  v_mfma_f32_16x16x32_bf16 v[140:143], a[84:87], v[44:47], v[140:143]
  ds_read_b64_tr_b16 a[78:79], v13 offset:6144
  s_add_u32 s31, s31, 12288
  s_cmp_eq_u32 s31, s33
  s_cselect_b32 s31, s34, s31
  v_mfma_f32_16x16x32_bf16 v[144:147], a[84:87], v[48:51], v[144:147]
  ds_read_b64_tr_b16 a[80:81], v14 offset:4096
  s_waitcnt lgkmcnt(5)
  v_mfma_f32_16x16x32_bf16 v[148:151], a[88:91], v[40:43], v[148:151]
  v_exp_f32 v92, v92
  v_mfma_f32_16x16x32_bf16 v[152:155], a[88:91], v[44:47], v[152:155]
  ds_read_b64_tr_b16 a[82:83], v14 offset:6144
  v_cvt_pk_bf16_f32 v53, v90, v91
  v_mfma_f32_16x16x32_bf16 v[156:159], a[88:91], v[48:51], v[156:159]
  ds_read_b64_tr_b16 a[84:85], v15 offset:4096
  s_waitcnt lgkmcnt(5)
  v_mfma_f32_16x16x32_bf16 v[160:163], a[72:75], v[40:43], v[160:163]
  v_exp_f32 v93, v93
  v_mfma_f32_16x16x32_bf16 v[164:167], a[72:75], v[44:47], v[164:167]
  ds_read_b64_tr_b16 a[86:87], v15 offset:6144
  s_add_u32 m0, s30, 0
  s_nop 0
  buffer_load_dwordx4 v16, s[20:23], s31 offen offset:0 lds
  v_mfma_f32_16x16x32_bf16 v[168:171], a[72:75], v[48:51], v[168:171]
  ds_read_b64_tr_b16 a[88:89], v12 offset:8192
  s_waitcnt lgkmcnt(5)
  v_mfma_f32_16x16x32_bf16 v[172:175], a[76:79], v[40:43], v[172:175]
  v_exp_f32 v94, v94
  v_mfma_f32_16x16x32_bf16 v[176:179], a[76:79], v[44:47], v[176:179]
  ds_read_b64_tr_b16 a[90:91], v12 offset:10240
  v_cvt_pk_bf16_f32 v56, v92, v93
  v_mfma_f32_16x16x32_bf16 v[180:183], a[76:79], v[48:51], v[180:183]
  ds_read_b64_tr_b16 a[72:73], v13 offset:8192
  s_waitcnt lgkmcnt(5)
  v_mfma_f32_16x16x32_bf16 v[184:187], a[80:83], v[40:43], v[184:187]
  v_exp_f32 v95, v95
  v_mfma_f32_16x16x32_bf16 v[188:191], a[80:83], v[44:47], v[188:191]
  ds_read_b64_tr_b16 a[74:75], v13 offset:10240
  buffer_load_dwordx4 v16, s[20:23], s31 offen offset:1024 lds
  v_mfma_f32_16x16x32_bf16 v[192:195], a[80:83], v[48:51], v[192:195]
  ds_read_b64_tr_b16 a[76:77], v14 offset:8192
  s_waitcnt lgkmcnt(5)
  v_mfma_f32_16x16x32_bf16 v[196:199], a[84:87], v[40:43], v[196:199]
  v_exp_f32 v96, v96
  v_mfma_f32_16x16x32_bf16 v[200:203], a[84:87], v[44:47], v[200:203]
  ds_read_b64_tr_b16 a[78:79], v14 offset:10240
  v_cvt_pk_bf16_f32 v57, v94, v95
  v_mfma_f32_16x16x32_bf16 v[204:207], a[84:87], v[48:51], v[204:207]
  ds_read_b64_tr_b16 a[80:81], v15 offset:8192
  s_waitcnt lgkmcnt(5)
  v_mfma_f32_16x16x32_bf16 v[208:211], a[88:91], v[40:43], v[208:211]
  v_exp_f32 v97, v97
  v_mfma_f32_16x16x32_bf16 v[212:215], a[88:91], v[44:47], v[212:215]
  ds_read_b64_tr_b16 a[82:83], v15 offset:10240
  buffer_load_dwordx4 v16, s[20:23], s31 offen offset:2048 lds
  v_mfma_f32_16x16x32_bf16 v[216:219], a[88:91], v[48:51], v[216:219]
  s_waitcnt lgkmcnt(4)
  v_mfma_f32_16x16x32_bf16 v[220:223], a[72:75], v[40:43], v[220:223]
  v_exp_f32 v98, v98
  v_mfma_f32_16x16x32_bf16 v[224:227], a[72:75], v[44:47], v[224:227]
  v_cvt_pk_bf16_f32 v60, v96, v97
  v_mfma_f32_16x16x32_bf16 v[228:231], a[72:75], v[48:51], v[228:231]
  s_waitcnt vmcnt(11)
  ds_read_b128 a[84:87], v10 offset:24576
  s_waitcnt lgkmcnt(3)
  v_mfma_f32_16x16x32_bf16 v[232:235], a[76:79], v[40:43], v[232:235]
  v_exp_f32 v99, v99
  v_mfma_f32_16x16x32_bf16 v[236:239], a[76:79], v[44:47], v[236:239]
  buffer_load_dwordx4 v16, s[20:23], s31 offen offset:3072 lds
  v_mfma_f32_16x16x32_bf16 v[240:243], a[76:79], v[48:51], v[240:243]
  ds_read_b128 a[88:91], v10 offset:26624
  s_waitcnt lgkmcnt(2)
  v_mfma_f32_16x16x32_bf16 v[244:247], a[80:83], v[40:43], v[244:247]
  v_exp_f32 v100, v100
  v_mfma_f32_16x16x32_bf16 v[248:251], a[80:83], v[44:47], v[248:251]
  v_cvt_pk_bf16_f32 v61, v98, v99
  v_mfma_f32_16x16x32_bf16 v[252:255], a[80:83], v[48:51], v[252:255]
  ds_read_b128 a[72:75], v11 offset:24576
  v_mfma_f32_16x16x32_bf16 a[104:107], a[116:119], v[40:43], a[104:107]
  v_exp_f32 v101, v101
  v_mfma_f32_16x16x32_bf16 a[108:111], a[116:119], v[44:47], a[108:111]
  s_add_u32 m0, s30, 4096
  s_nop 0
  buffer_load_dwordx4 v17, s[20:23], s31 offen offset:0 lds
  v_mfma_f32_16x16x32_bf16 a[112:115], a[116:119], v[48:51], a[112:115]
  ds_read_b128 a[76:79], v11 offset:26624
  s_waitcnt lgkmcnt(3)
  v_mfma_f32_16x16x32_bf16 v[64:67], a[84:87], a[0:3], v[28:31]
  v_exp_f32 v102, v102
  v_mfma_f32_16x16x32_bf16 v[68:71], a[84:87], a[24:27], v[32:35]
  v_cvt_pk_bf16_f32 v54, v100, v101
  v_mfma_f32_16x16x32_bf16 v[72:75], a[84:87], a[48:51], v[36:39]
  s_waitcnt vmcnt(9)
  ds_read_b128 a[80:83], v10 offset:28672
  s_waitcnt lgkmcnt(3)
  v_mfma_f32_16x16x32_bf16 v[76:79], a[88:91], a[0:3], v[28:31]
  v_exp_f32 v103, v103
  v_mfma_f32_16x16x32_bf16 v[80:83], a[88:91], a[24:27], v[32:35]
  buffer_load_dwordx4 v17, s[20:23], s31 offen offset:1024 lds
  v_mfma_f32_16x16x32_bf16 v[84:87], a[88:91], a[48:51], v[36:39]
  ds_read_b128 a[84:87], v10 offset:30720
  s_waitcnt lgkmcnt(3)
  v_mfma_f32_16x16x32_bf16 v[64:67], a[72:75], a[4:7], v[64:67]
  v_exp_f32 v104, v104
  v_mfma_f32_16x16x32_bf16 v[68:71], a[72:75], a[28:31], v[68:71]
  v_cvt_pk_bf16_f32 v55, v102, v103
  v_mfma_f32_16x16x32_bf16 v[72:75], a[72:75], a[52:55], v[72:75]
  ds_read_b128 a[88:91], v11 offset:28672
  s_waitcnt lgkmcnt(3)
  v_mfma_f32_16x16x32_bf16 v[76:79], a[76:79], a[4:7], v[76:79]
  v_exp_f32 v105, v105
  v_mfma_f32_16x16x32_bf16 v[80:83], a[76:79], a[28:31], v[80:83]
  buffer_load_dwordx4 v17, s[20:23], s31 offen offset:2048 lds
  v_mfma_f32_16x16x32_bf16 v[84:87], a[76:79], a[52:55], v[84:87]
  ds_read_b128 a[72:75], v11 offset:30720
  s_waitcnt lgkmcnt(3)
  v_mfma_f32_16x16x32_bf16 v[64:67], a[80:83], a[8:11], v[64:67]
  v_exp_f32 v106, v106
  v_mfma_f32_16x16x32_bf16 v[68:71], a[80:83], a[32:35], v[68:71]
  v_cvt_pk_bf16_f32 v58, v104, v105
  v_mfma_f32_16x16x32_bf16 v[72:75], a[80:83], a[56:59], v[72:75]
  s_waitcnt vmcnt(7)
  ds_read_b128 a[76:79], v10 offset:32768
  s_waitcnt lgkmcnt(3)
  v_mfma_f32_16x16x32_bf16 v[76:79], a[84:87], a[8:11], v[76:79]
  v_exp_f32 v107, v107
  v_mfma_f32_16x16x32_bf16 v[80:83], a[84:87], a[32:35], v[80:83]
  buffer_load_dwordx4 v17, s[20:23], s31 offen offset:3072 lds
  v_mfma_f32_16x16x32_bf16 v[84:87], a[84:87], a[56:59], v[84:87]
  ds_read_b128 a[80:83], v10 offset:34816
  s_waitcnt lgkmcnt(3)
  v_mfma_f32_16x16x32_bf16 v[64:67], a[88:91], a[12:15], v[64:67]
  v_exp_f32 v108, v108
  v_mfma_f32_16x16x32_bf16 v[68:71], a[88:91], a[36:39], v[68:71]
  v_cvt_pk_bf16_f32 v59, v106, v107
  v_mfma_f32_16x16x32_bf16 v[72:75], a[88:91], a[60:63], v[72:75]
  ds_read_b128 a[84:87], v11 offset:32768
  s_waitcnt lgkmcnt(3)
  v_mfma_f32_16x16x32_bf16 v[76:79], a[72:75], a[12:15], v[76:79]
  v_exp_f32 v109, v109
  v_mfma_f32_16x16x32_bf16 v[80:83], a[72:75], a[36:39], v[80:83]
  s_add_u32 m0, s30, 8192
  s_nop 0
  buffer_load_dwordx4 v18, s[20:23], s31 offen offset:0 lds
  v_mfma_f32_16x16x32_bf16 v[84:87], a[72:75], a[60:63], v[84:87]
  ds_read_b128 a[88:91], v11 offset:34816
  s_waitcnt lgkmcnt(3)
  v_mfma_f32_16x16x32_bf16 v[64:67], a[76:79], a[16:19], v[64:67]
  v_exp_f32 v110, v110
  v_mfma_f32_16x16x32_bf16 v[68:71], a[76:79], a[40:43], v[68:71]
  v_cvt_pk_bf16_f32 v62, v108, v109
  v_mfma_f32_16x16x32_bf16 v[72:75], a[76:79], a[64:67], v[72:75]
  ds_read_b64_tr_b16 a[72:73], v12 offset:12288
  s_waitcnt lgkmcnt(3)
  v_mfma_f32_16x16x32_bf16 v[76:79], a[80:83], a[16:19], v[76:79]
  v_exp_f32 v111, v111
  v_mfma_f32_16x16x32_bf16 v[80:83], a[80:83], a[40:43], v[80:83]
  ds_read_b64_tr_b16 a[74:75], v12 offset:14336
  buffer_load_dwordx4 v18, s[20:23], s31 offen offset:1024 lds
  v_mfma_f32_16x16x32_bf16 v[84:87], a[80:83], a[64:67], v[84:87]
  ds_read_b64_tr_b16 a[76:77], v13 offset:12288
  s_waitcnt lgkmcnt(4)
  v_mfma_f32_16x16x32_bf16 v[64:67], a[84:87], a[20:23], v[64:67]
  v_cvt_pk_bf16_f32 v63, v110, v111
  v_mfma_f32_16x16x32_bf16 v[68:71], a[84:87], a[44:47], v[68:71]
  ds_read_b64_tr_b16 a[78:79], v13 offset:14336
  v_mfma_f32_16x16x32_bf16 v[72:75], a[84:87], a[68:71], v[72:75]
  ds_read_b64_tr_b16 a[80:81], v14 offset:12288
  s_waitcnt lgkmcnt(5)
  v_mfma_f32_16x16x32_bf16 v[76:79], a[88:91], a[20:23], v[76:79]
  v_mfma_f32_16x16x32_bf16 v[80:83], a[88:91], a[44:47], v[80:83]
  ds_read_b64_tr_b16 a[82:83], v14 offset:14336
  buffer_load_dwordx4 v18, s[20:23], s31 offen offset:2048 lds
  v_mfma_f32_16x16x32_bf16 v[84:87], a[88:91], a[68:71], v[84:87]
  ds_read_b64_tr_b16 a[84:85], v15 offset:12288
  s_waitcnt lgkmcnt(5)
  v_mfma_f32_16x16x32_bf16 v[112:115], a[72:75], v[52:55], v[112:115]
  v_exp_f32 v64, v64
  v_mfma_f32_16x16x32_bf16 v[116:119], a[72:75], v[56:59], v[116:119]
  ds_read_b64_tr_b16 a[86:87], v15 offset:14336
  v_exp_f32 v65, v65
  v_mfma_f32_16x16x32_bf16 v[120:123], a[72:75], v[60:63], v[120:123]
  ds_read_b64_tr_b16 a[88:89], v12 offset:16384
  s_waitcnt lgkmcnt(5)
  v_mfma_f32_16x16x32_bf16 v[124:127], a[76:79], v[52:55], v[124:127]
  v_exp_f32 v66, v66
  v_mfma_f32_16x16x32_bf16 v[128:131], a[76:79], v[56:59], v[128:131]
  ds_read_b64_tr_b16 a[90:91], v12 offset:18432
  buffer_load_dwordx4 v18, s[20:23], s31 offen offset:3072 lds
  v_cvt_pk_bf16_f32 v40, v64, v65
  v_mfma_f32_16x16x32_bf16 v[132:135], a[76:79], v[60:63], v[132:135]
  ds_read_b64_tr_b16 a[72:73], v13 offset:16384
  s_waitcnt lgkmcnt(5)
  v_mfma_f32_16x16x32_bf16 v[136:139], a[80:83], v[52:55], v[136:139]
  v_exp_f32 v67, v67
  v_mfma_f32_16x16x32_bf16 v[140:143], a[80:83], v[56:59], v[140:143]
  ds_read_b64_tr_b16 a[74:75], v13 offset:18432
  s_add_u32 s31, s31, 12288
  s_cmp_eq_u32 s31, s33
  s_cselect_b32 s31, s34, s31
  s_mul_i32 s27, s24, 18432
  s_add_u32 s27, s27, 9043968
  s_add_u32 s28, s27, 12288
  v_mfma_f32_16x16x32_bf16 v[144:147], a[80:83], v[60:63], v[144:147]
  ds_read_b64_tr_b16 a[76:77], v14 offset:16384
  s_waitcnt lgkmcnt(5)
  v_mfma_f32_16x16x32_bf16 v[148:151], a[84:87], v[52:55], v[148:151]
  v_exp_f32 v68, v68
  v_mfma_f32_16x16x32_bf16 v[152:155], a[84:87], v[56:59], v[152:155]
  ds_read_b64_tr_b16 a[78:79], v14 offset:18432
  buffer_load_dwordx4 a[128:131], v16, s[20:23], s27 offen offset:0
  v_cvt_pk_bf16_f32 v41, v66, v67
  v_mfma_f32_16x16x32_bf16 v[156:159], a[84:87], v[60:63], v[156:159]
  ds_read_b64_tr_b16 a[80:81], v15 offset:16384
  s_waitcnt lgkmcnt(5)
  v_mfma_f32_16x16x32_bf16 v[160:163], a[88:91], v[52:55], v[160:163]
  v_exp_f32 v69, v69
  v_mfma_f32_16x16x32_bf16 v[164:167], a[88:91], v[56:59], v[164:167]
  ds_read_b64_tr_b16 a[82:83], v15 offset:18432
  buffer_load_dwordx4 a[132:135], v16, s[20:23], s27 offen offset:1024
  v_mfma_f32_16x16x32_bf16 v[168:171], a[88:91], v[60:63], v[168:171]
  ds_read_b64_tr_b16 a[84:85], v12 offset:20480
  s_waitcnt lgkmcnt(5)
  v_mfma_f32_16x16x32_bf16 v[172:175], a[72:75], v[52:55], v[172:175]
  v_exp_f32 v70, v70
  v_mfma_f32_16x16x32_bf16 v[176:179], a[72:75], v[56:59], v[176:179]
  ds_read_b64_tr_b16 a[86:87], v12 offset:22528
  buffer_load_dwordx4 a[136:139], v16, s[20:23], s27 offen offset:2048
  v_cvt_pk_bf16_f32 v44, v68, v69
  v_mfma_f32_16x16x32_bf16 v[180:183], a[72:75], v[60:63], v[180:183]
  ds_read_b64_tr_b16 a[88:89], v13 offset:20480
  s_waitcnt lgkmcnt(5)
  v_mfma_f32_16x16x32_bf16 v[184:187], a[76:79], v[52:55], v[184:187]
  v_exp_f32 v71, v71
  v_mfma_f32_16x16x32_bf16 v[188:191], a[76:79], v[56:59], v[188:191]
  ds_read_b64_tr_b16 a[90:91], v13 offset:22528
  buffer_load_dwordx4 a[140:143], v16, s[20:23], s27 offen offset:3072
  v_mfma_f32_16x16x32_bf16 v[192:195], a[76:79], v[60:63], v[192:195]
  ds_read_b64_tr_b16 a[72:73], v14 offset:20480
  s_waitcnt lgkmcnt(5)
  v_mfma_f32_16x16x32_bf16 v[196:199], a[80:83], v[52:55], v[196:199]
  v_exp_f32 v72, v72
  v_mfma_f32_16x16x32_bf16 v[200:203], a[80:83], v[56:59], v[200:203]
  ds_read_b64_tr_b16 a[74:75], v14 offset:22528
  buffer_load_dwordx4 a[144:147], v17, s[20:23], s27 offen offset:0
  v_cvt_pk_bf16_f32 v45, v70, v71
  v_mfma_f32_16x16x32_bf16 v[204:207], a[80:83], v[60:63], v[204:207]
  ds_read_b64_tr_b16 a[76:77], v15 offset:20480
  s_waitcnt lgkmcnt(5)
  v_mfma_f32_16x16x32_bf16 v[208:211], a[84:87], v[52:55], v[208:211]
  v_exp_f32 v73, v73
  v_mfma_f32_16x16x32_bf16 v[212:215], a[84:87], v[56:59], v[212:215]
  ds_read_b64_tr_b16 a[78:79], v15 offset:22528
  buffer_load_dwordx4 a[148:151], v17, s[20:23], s27 offen offset:1024
  v_mfma_f32_16x16x32_bf16 v[216:219], a[84:87], v[60:63], v[216:219]
  s_waitcnt lgkmcnt(4)
  v_mfma_f32_16x16x32_bf16 v[220:223], a[88:91], v[52:55], v[220:223]
  v_exp_f32 v74, v74
  v_mfma_f32_16x16x32_bf16 v[224:227], a[88:91], v[56:59], v[224:227]
  buffer_load_dwordx4 a[152:155], v17, s[20:23], s27 offen offset:2048
  v_cvt_pk_bf16_f32 v48, v72, v73
  v_mfma_f32_16x16x32_bf16 v[228:231], a[88:91], v[60:63], v[228:231]
  s_waitcnt vmcnt(15)
  ds_read_b128 a[80:83], v10 offset:0
  s_waitcnt lgkmcnt(3)
  v_mfma_f32_16x16x32_bf16 v[232:235], a[72:75], v[52:55], v[232:235]
  v_exp_f32 v75, v75
  v_mfma_f32_16x16x32_bf16 v[236:239], a[72:75], v[56:59], v[236:239]
  buffer_load_dwordx4 a[156:159], v17, s[20:23], s27 offen offset:3072
  v_mfma_f32_16x16x32_bf16 v[240:243], a[72:75], v[60:63], v[240:243]
  ds_read_b128 a[84:87], v10 offset:2048
  s_waitcnt lgkmcnt(2)
  v_mfma_f32_16x16x32_bf16 v[244:247], a[76:79], v[52:55], v[244:247]
  v_exp_f32 v76, v76
  v_mfma_f32_16x16x32_bf16 v[248:251], a[76:79], v[56:59], v[248:251]
  buffer_load_dwordx4 a[160:163], v18, s[20:23], s27 offen offset:0
  v_cvt_pk_bf16_f32 v49, v74, v75
  v_mfma_f32_16x16x32_bf16 v[252:255], a[76:79], v[60:63], v[252:255]
  ds_read_b128 a[88:91], v11 offset:0
  v_mfma_f32_16x16x32_bf16 a[104:107], a[116:119], v[52:55], a[104:107]
  v_exp_f32 v77, v77
  v_mfma_f32_16x16x32_bf16 a[108:111], a[116:119], v[56:59], a[108:111]
  buffer_load_dwordx4 a[164:167], v18, s[20:23], s27 offen offset:1024
  v_mfma_f32_16x16x32_bf16 a[112:115], a[116:119], v[60:63], a[112:115]
  ds_read_b128 a[72:75], v11 offset:2048
  s_waitcnt lgkmcnt(3)
  v_mfma_f32_16x16x32_bf16 v[88:91], a[80:83], a[0:3], v[28:31]
  v_exp_f32 v78, v78
  v_mfma_f32_16x16x32_bf16 v[92:95], a[80:83], a[24:27], v[32:35]
  buffer_load_dwordx4 a[168:171], v18, s[20:23], s27 offen offset:2048
  v_cvt_pk_bf16_f32 v42, v76, v77
  v_mfma_f32_16x16x32_bf16 v[96:99], a[80:83], a[48:51], v[36:39]
  s_waitcnt vmcnt(15)
  ds_read_b128 a[76:79], v10 offset:4096
  s_waitcnt lgkmcnt(3)
  v_mfma_f32_16x16x32_bf16 v[100:103], a[84:87], a[0:3], v[28:31]
  v_exp_f32 v79, v79
  v_mfma_f32_16x16x32_bf16 v[104:107], a[84:87], a[24:27], v[32:35]
  buffer_load_dwordx4 a[172:175], v18, s[20:23], s27 offen offset:3072
  v_mfma_f32_16x16x32_bf16 v[108:111], a[84:87], a[48:51], v[36:39]
  ds_read_b128 a[80:83], v10 offset:6144
  s_waitcnt lgkmcnt(3)
  v_mfma_f32_16x16x32_bf16 v[88:91], a[88:91], a[4:7], v[88:91]
  v_exp_f32 v80, v80
  v_mfma_f32_16x16x32_bf16 v[92:95], a[88:91], a[28:31], v[92:95]
  buffer_load_dwordx4 a[176:179], v16, s[20:23], s28 offen offset:0
  v_cvt_pk_bf16_f32 v43, v78, v79
  v_mfma_f32_16x16x32_bf16 v[96:99], a[88:91], a[52:55], v[96:99]
  ds_read_b128 a[84:87], v11 offset:4096
  s_waitcnt lgkmcnt(3)
  v_mfma_f32_16x16x32_bf16 v[100:103], a[72:75], a[4:7], v[100:103]
  v_exp_f32 v81, v81
  v_mfma_f32_16x16x32_bf16 v[104:107], a[72:75], a[28:31], v[104:107]
  buffer_load_dwordx4 a[180:183], v16, s[20:23], s28 offen offset:1024
  v_mfma_f32_16x16x32_bf16 v[108:111], a[72:75], a[52:55], v[108:111]
  ds_read_b128 a[88:91], v11 offset:6144
  s_waitcnt lgkmcnt(3)
  v_mfma_f32_16x16x32_bf16 v[88:91], a[76:79], a[8:11], v[88:91]
  v_exp_f32 v82, v82
  v_mfma_f32_16x16x32_bf16 v[92:95], a[76:79], a[32:35], v[92:95]
  buffer_load_dwordx4 a[184:187], v16, s[20:23], s28 offen offset:2048
  v_cvt_pk_bf16_f32 v46, v80, v81
  v_mfma_f32_16x16x32_bf16 v[96:99], a[76:79], a[56:59], v[96:99]
  s_waitcnt vmcnt(15)
  ds_read_b128 a[72:75], v10 offset:8192
  s_waitcnt lgkmcnt(3)
  v_mfma_f32_16x16x32_bf16 v[100:103], a[80:83], a[8:11], v[100:103]
  v_exp_f32 v83, v83
  v_mfma_f32_16x16x32_bf16 v[104:107], a[80:83], a[32:35], v[104:107]
  buffer_load_dwordx4 a[188:191], v16, s[20:23], s28 offen offset:3072
  v_mfma_f32_16x16x32_bf16 v[108:111], a[80:83], a[56:59], v[108:111]
  ds_read_b128 a[76:79], v10 offset:10240
  s_waitcnt lgkmcnt(3)
  v_mfma_f32_16x16x32_bf16 v[88:91], a[84:87], a[12:15], v[88:91]
  v_exp_f32 v84, v84
  v_mfma_f32_16x16x32_bf16 v[92:95], a[84:87], a[36:39], v[92:95]
  buffer_load_dwordx4 a[192:195], v17, s[20:23], s28 offen offset:0
  v_cvt_pk_bf16_f32 v47, v82, v83
  v_mfma_f32_16x16x32_bf16 v[96:99], a[84:87], a[60:63], v[96:99]
  ds_read_b128 a[80:83], v11 offset:8192
  s_waitcnt lgkmcnt(3)
  v_mfma_f32_16x16x32_bf16 v[100:103], a[88:91], a[12:15], v[100:103]
  v_exp_f32 v85, v85
  v_mfma_f32_16x16x32_bf16 v[104:107], a[88:91], a[36:39], v[104:107]
  buffer_load_dwordx4 a[196:199], v17, s[20:23], s28 offen offset:1024
  v_mfma_f32_16x16x32_bf16 v[108:111], a[88:91], a[60:63], v[108:111]
  ds_read_b128 a[84:87], v11 offset:10240
  s_waitcnt lgkmcnt(3)
  v_mfma_f32_16x16x32_bf16 v[88:91], a[72:75], a[16:19], v[88:91]
  v_exp_f32 v86, v86
  v_mfma_f32_16x16x32_bf16 v[92:95], a[72:75], a[40:43], v[92:95]
  v_cvt_pk_bf16_f32 v50, v84, v85
  v_mfma_f32_16x16x32_bf16 v[96:99], a[72:75], a[64:67], v[96:99]
  ds_read_b64_tr_b16 a[88:89], v12 offset:24576
  s_waitcnt lgkmcnt(3)
  v_mfma_f32_16x16x32_bf16 v[100:103], a[76:79], a[16:19], v[100:103]
  v_exp_f32 v87, v87
  v_mfma_f32_16x16x32_bf16 v[104:107], a[76:79], a[40:43], v[104:107]
  ds_read_b64_tr_b16 a[90:91], v12 offset:26624
  v_mfma_f32_16x16x32_bf16 v[108:111], a[76:79], a[64:67], v[108:111]
  ds_read_b64_tr_b16 a[72:73], v13 offset:24576
  s_waitcnt lgkmcnt(4)
  v_mfma_f32_16x16x32_bf16 v[88:91], a[80:83], a[20:23], v[88:91]
  v_cvt_pk_bf16_f32 v51, v86, v87
  s_mov_b32 s41, 4194304
  v_mfma_f32_16x16x32_bf16 v[92:95], a[80:83], a[44:47], v[92:95]
  ds_read_b64_tr_b16 a[74:75], v13 offset:26624
  v_accvgpr_read_b32 v7, a102
  v_mfma_f32_16x16x32_bf16 v[96:99], a[80:83], a[68:71], v[96:99]
  ds_read_b64_tr_b16 a[76:77], v14 offset:24576
  s_waitcnt lgkmcnt(5)
  v_mfma_f32_16x16x32_bf16 v[100:103], a[84:87], a[20:23], v[100:103]
  v_accvgpr_read_b32 v8, a96
  v_accvgpr_read_b32 v9, a97
  v_mfma_f32_16x16x32_bf16 v[104:107], a[84:87], a[44:47], v[104:107]
  ds_read_b64_tr_b16 a[78:79], v14 offset:26624
  v_mfma_f32_16x16x32_bf16 v[108:111], a[84:87], a[68:71], v[108:111]
  ds_read_b64_tr_b16 a[80:81], v15 offset:24576
  s_waitcnt lgkmcnt(5)
  v_mfma_f32_16x16x32_bf16 v[112:115], a[88:91], v[40:43], v[112:115]
  v_exp_f32 v88, v88
  v_mfma_f32_16x16x32_bf16 v[116:119], a[88:91], v[44:47], v[116:119]
  ds_read_b64_tr_b16 a[82:83], v15 offset:26624
  buffer_load_dwordx4 v[64:67], v8, s[20:23], s32 offen
  v_exp_f32 v89, v89
  v_exp_f32 v90, v90
  v_mfma_f32_16x16x32_bf16 v[120:123], a[88:91], v[48:51], v[120:123]
  ds_read_b64_tr_b16 a[84:85], v12 offset:28672
  s_waitcnt lgkmcnt(5)
  v_mfma_f32_16x16x32_bf16 v[124:127], a[72:75], v[40:43], v[124:127]
  v_exp_f32 v91, v91
  v_mfma_f32_16x16x32_bf16 v[128:131], a[72:75], v[44:47], v[128:131]
  ds_read_b64_tr_b16 a[86:87], v12 offset:30720
  buffer_load_dwordx2 v[68:69], v9, s[20:23], s32 offen
  v_exp_f32 v92, v92
  v_cvt_pk_bf16_f32 v52, v88, v89
  v_mfma_f32_16x16x32_bf16 v[132:135], a[72:75], v[48:51], v[132:135]
  ds_read_b64_tr_b16 a[88:89], v13 offset:28672
  s_waitcnt lgkmcnt(5)
  v_mfma_f32_16x16x32_bf16 v[136:139], a[76:79], v[40:43], v[136:139]
  v_exp_f32 v93, v93
  v_mfma_f32_16x16x32_bf16 v[140:143], a[76:79], v[44:47], v[140:143]
  ds_read_b64_tr_b16 a[90:91], v13 offset:30720
  buffer_load_dwordx2 v[82:83], v7, s[20:23], s41 offen offset:0
  v_exp_f32 v94, v94
  v_cvt_pk_bf16_f32 v53, v90, v91
  v_accvgpr_read_b32 v8, a98
  v_accvgpr_read_b32 v9, a99
  v_mfma_f32_16x16x32_bf16 v[144:147], a[76:79], v[48:51], v[144:147]
  ds_read_b64_tr_b16 a[72:73], v14 offset:28672
  s_waitcnt lgkmcnt(5)
  v_mfma_f32_16x16x32_bf16 v[148:151], a[80:83], v[40:43], v[148:151]
  v_exp_f32 v95, v95
  v_mfma_f32_16x16x32_bf16 v[152:155], a[80:83], v[44:47], v[152:155]
  ds_read_b64_tr_b16 a[74:75], v14 offset:30720
  buffer_load_dwordx4 v[70:73], v8, s[20:23], s32 offen
  v_exp_f32 v96, v96
  v_cvt_pk_bf16_f32 v56, v92, v93
  v_mfma_f32_16x16x32_bf16 v[156:159], a[80:83], v[48:51], v[156:159]
  ds_read_b64_tr_b16 a[76:77], v15 offset:28672
  s_waitcnt lgkmcnt(5)
  v_mfma_f32_16x16x32_bf16 v[160:163], a[84:87], v[40:43], v[160:163]
  v_exp_f32 v97, v97
  v_mfma_f32_16x16x32_bf16 v[164:167], a[84:87], v[44:47], v[164:167]
  ds_read_b64_tr_b16 a[78:79], v15 offset:30720
  buffer_load_dwordx2 v[74:75], v9, s[20:23], s32 offen
  v_exp_f32 v98, v98
  v_cvt_pk_bf16_f32 v57, v94, v95
  v_mfma_f32_16x16x32_bf16 v[168:171], a[84:87], v[48:51], v[168:171]
  ds_read_b64_tr_b16 a[80:81], v12 offset:32768
  s_waitcnt lgkmcnt(5)
  v_mfma_f32_16x16x32_bf16 v[172:175], a[88:91], v[40:43], v[172:175]
  v_exp_f32 v99, v99
  v_mfma_f32_16x16x32_bf16 v[176:179], a[88:91], v[44:47], v[176:179]
  ds_read_b64_tr_b16 a[82:83], v12 offset:34816
  buffer_load_dwordx2 v[84:85], v7, s[20:23], s41 offen offset:128
  v_exp_f32 v100, v100
  v_exp_f32 v101, v101
  v_cvt_pk_bf16_f32 v60, v96, v97
  v_accvgpr_read_b32 v8, a100
  v_accvgpr_read_b32 v9, a101
  v_mfma_f32_16x16x32_bf16 v[180:183], a[88:91], v[48:51], v[180:183]
  ds_read_b64_tr_b16 a[84:85], v13 offset:32768
  s_waitcnt lgkmcnt(5)
  v_mfma_f32_16x16x32_bf16 v[184:187], a[72:75], v[40:43], v[184:187]
  v_exp_f32 v102, v102
  v_mfma_f32_16x16x32_bf16 v[188:191], a[72:75], v[44:47], v[188:191]
  ds_read_b64_tr_b16 a[86:87], v13 offset:34816
  buffer_load_dwordx4 v[76:79], v8, s[20:23], s32 offen
  v_exp_f32 v103, v103
  v_cvt_pk_bf16_f32 v61, v98, v99
  v_cvt_pk_bf16_f32 v54, v100, v101
  v_mfma_f32_16x16x32_bf16 v[192:195], a[72:75], v[48:51], v[192:195]
  ds_read_b64_tr_b16 a[88:89], v14 offset:32768
  s_waitcnt lgkmcnt(5)
  v_mfma_f32_16x16x32_bf16 v[196:199], a[76:79], v[40:43], v[196:199]
  v_exp_f32 v104, v104
  v_mfma_f32_16x16x32_bf16 v[200:203], a[76:79], v[44:47], v[200:203]
  ds_read_b64_tr_b16 a[90:91], v14 offset:34816
  buffer_load_dwordx2 v[80:81], v9, s[20:23], s32 offen
  v_exp_f32 v105, v105
  v_cvt_pk_bf16_f32 v55, v102, v103
  v_mfma_f32_16x16x32_bf16 v[204:207], a[76:79], v[48:51], v[204:207]
  ds_read_b64_tr_b16 a[72:73], v15 offset:32768
  s_waitcnt lgkmcnt(5)
  v_mfma_f32_16x16x32_bf16 v[208:211], a[80:83], v[40:43], v[208:211]
  v_exp_f32 v106, v106
  v_mfma_f32_16x16x32_bf16 v[212:215], a[80:83], v[44:47], v[212:215]
  ds_read_b64_tr_b16 a[74:75], v15 offset:34816
  buffer_load_dwordx2 v[86:87], v7, s[20:23], s41 offen offset:256
  v_exp_f32 v107, v107
  v_cvt_pk_bf16_f32 v58, v104, v105
  v_mfma_f32_16x16x32_bf16 v[216:219], a[80:83], v[48:51], v[216:219]
  s_waitcnt lgkmcnt(4)
  v_mfma_f32_16x16x32_bf16 v[220:223], a[84:87], v[40:43], v[220:223]
  v_exp_f32 v108, v108
  v_mfma_f32_16x16x32_bf16 v[224:227], a[84:87], v[44:47], v[224:227]
  v_exp_f32 v109, v109
  v_cvt_pk_bf16_f32 v59, v106, v107
  v_mfma_f32_16x16x32_bf16 v[228:231], a[84:87], v[48:51], v[228:231]
  ds_read_b64_tr_b16 a[76:77], v13 offset:0
  s_waitcnt lgkmcnt(3)
  v_mfma_f32_16x16x32_bf16 v[232:235], a[88:91], v[40:43], v[232:235]
  v_exp_f32 v110, v110
  v_mfma_f32_16x16x32_bf16 v[236:239], a[88:91], v[44:47], v[236:239]
  ds_read_b64_tr_b16 a[78:79], v13 offset:2048
  v_exp_f32 v111, v111
  v_cvt_pk_bf16_f32 v62, v108, v109
  v_mfma_f32_16x16x32_bf16 v[240:243], a[88:91], v[48:51], v[240:243]
  ds_read_b64_tr_b16 a[80:81], v14 offset:0
  s_waitcnt lgkmcnt(3)
  v_mfma_f32_16x16x32_bf16 v[244:247], a[72:75], v[40:43], v[244:247]
  v_cvt_pk_bf16_f32 v63, v110, v111
  v_mfma_f32_16x16x32_bf16 v[248:251], a[72:75], v[44:47], v[248:251]
  ds_read_b64_tr_b16 a[82:83], v14 offset:2048
  v_mfma_f32_16x16x32_bf16 v[252:255], a[72:75], v[48:51], v[252:255]
  ds_read_b64_tr_b16 a[84:85], v15 offset:0
  v_mfma_f32_16x16x32_bf16 a[104:107], a[116:119], v[40:43], a[104:107]
  v_lshlrev_b32 v4, 3, v1
  v_add_u32 v4, s30, v4
  v_mfma_f32_16x16x32_bf16 a[108:111], a[116:119], v[44:47], a[108:111]
  ds_read_b64_tr_b16 a[86:87], v15 offset:2048
  ds_read_b64_tr_b16 a[212:213], v13 offset:4096
  ds_read_b64_tr_b16 a[214:215], v13 offset:6144
  ds_read_b64_tr_b16 a[216:217], v14 offset:4096
  ds_read_b64_tr_b16 a[218:219], v14 offset:6144
  ds_read_b64_tr_b16 a[220:221], v15 offset:4096
  ds_read_b64_tr_b16 a[222:223], v15 offset:6144
  v_mfma_f32_16x16x32_bf16 a[112:115], a[116:119], v[48:51], a[112:115]
  s_waitcnt lgkmcnt(10)
  v_mfma_f32_16x16x32_bf16 v[124:127], a[76:79], v[52:55], v[124:127]
  v_lshlrev_b32 v5, 4, v3
  s_lshl_b32 s27, s24, 2
  v_mfma_f32_16x16x32_bf16 v[128:131], a[76:79], v[56:59], v[128:131]
  ds_read_b64_tr_b16 a[224:225], v13 offset:8192
  ds_read_b64_tr_b16 a[226:227], v13 offset:10240
  ds_read_b64_tr_b16 a[228:229], v14 offset:8192
  ds_read_b64_tr_b16 a[230:231], v14 offset:10240
  ds_read_b64_tr_b16 a[232:233], v15 offset:8192
  ds_read_b64_tr_b16 a[234:235], v15 offset:10240
  s_add_u32 s27, s27, 161792
  v_add_u32 v6, s27, v5
  v_add_u32 v5, 161792, v5
  s_xor_b32 s27, s24, 1
  s_mul_i32 s27, s27, 36864
  v_lshlrev_b32 v7, 3, v1
  v_add_u32 v7, s27, v7
  v_mfma_f32_16x16x32_bf16 v[132:135], a[76:79], v[60:63], v[132:135]
  s_waitcnt lgkmcnt(14)
  v_mfma_f32_16x16x32_bf16 v[136:139], a[80:83], v[52:55], v[136:139]
  s_xor_b32 s27, s24, 2
  s_mul_i32 s27, s27, 36864
  v_mfma_f32_16x16x32_bf16 v[140:143], a[80:83], v[56:59], v[140:143]
  ds_read_b64_tr_b16 a[236:237], v12 offset:0
  ds_read_b64_tr_b16 a[238:239], v12 offset:2048
  ds_read_b64_tr_b16 a[240:241], v12 offset:4096
  ds_read_b64_tr_b16 a[242:243], v12 offset:6144
  ds_read_b64_tr_b16 a[244:245], v12 offset:8192
  ds_read_b64_tr_b16 a[246:247], v12 offset:10240
  v_lshlrev_b32 v8, 3, v1
  v_add_u32 v8, s27, v8
  s_xor_b32 s27, s24, 3
  s_mul_i32 s27, s27, 36864
  v_lshlrev_b32 v9, 3, v1
  v_add_u32 v9, s27, v9
  v_mfma_f32_16x16x32_bf16 v[144:147], a[80:83], v[60:63], v[144:147]
  s_waitcnt lgkmcnt(14)
  v_mfma_f32_16x16x32_bf16 v[148:151], a[84:87], v[52:55], v[148:151]
  v_cvt_pk_bf16_f32 v124, v124, v125
  v_cvt_pk_bf16_f32 v125, v126, v127
  v_mfma_f32_16x16x32_bf16 v[152:155], a[84:87], v[56:59], v[152:155]
  ds_write_b64 v4, v[124:125] offset:12288
  v_cvt_pk_bf16_f32 v128, v128, v129
  v_cvt_pk_bf16_f32 v129, v130, v131
  ds_write_b64 v4, v[128:129] offset:12800
  v_cvt_pk_bf16_f32 v132, v132, v133
  v_cvt_pk_bf16_f32 v133, v134, v135
  ds_write_b64 v4, v[132:133] offset:13312
  v_mfma_f32_16x16x32_bf16 v[156:159], a[84:87], v[60:63], v[156:159]
  v_mfma_f32_16x16x32_bf16 v[172:175], a[212:215], v[52:55], v[172:175]
  v_cvt_pk_bf16_f32 v136, v136, v137
  v_cvt_pk_bf16_f32 v137, v138, v139
  v_mfma_f32_16x16x32_bf16 v[176:179], a[212:215], v[56:59], v[176:179]
  ds_write_b64 v4, v[136:137] offset:16896
  v_cvt_pk_bf16_f32 v140, v140, v141
  v_cvt_pk_bf16_f32 v141, v142, v143
  ds_write_b64 v4, v[140:141] offset:17408
  v_mfma_f32_16x16x32_bf16 v[180:183], a[212:215], v[60:63], v[180:183]
  v_mfma_f32_16x16x32_bf16 v[184:187], a[216:219], v[52:55], v[184:187]
  v_cvt_pk_bf16_f32 v144, v144, v145
  v_cvt_pk_bf16_f32 v145, v146, v147
  v_mfma_f32_16x16x32_bf16 v[188:191], a[216:219], v[56:59], v[188:191]
  ds_write_b64 v4, v[144:145] offset:17920
  v_cvt_pk_bf16_f32 v148, v148, v149
  v_cvt_pk_bf16_f32 v149, v150, v151
  ds_write_b64 v4, v[148:149] offset:21504
  v_cvt_pk_bf16_f32 v152, v152, v153
  v_cvt_pk_bf16_f32 v153, v154, v155
  ds_write_b64 v4, v[152:153] offset:22016
  v_mfma_f32_16x16x32_bf16 v[192:195], a[216:219], v[60:63], v[192:195]
  s_waitcnt lgkmcnt(14)
  v_mfma_f32_16x16x32_bf16 v[196:199], a[220:223], v[52:55], v[196:199]
  v_cvt_pk_bf16_f32 v156, v156, v157
  v_cvt_pk_bf16_f32 v157, v158, v159
  v_mfma_f32_16x16x32_bf16 v[200:203], a[220:223], v[56:59], v[200:203]
  ds_write_b64 v4, v[156:157] offset:22528
  v_cvt_pk_bf16_f32 v172, v172, v173
  v_cvt_pk_bf16_f32 v173, v174, v175
  ds_write_b64 v4, v[172:173] offset:13824
  v_mfma_f32_16x16x32_bf16 v[204:207], a[220:223], v[60:63], v[204:207]
  v_mfma_f32_16x16x32_bf16 v[220:223], a[224:227], v[52:55], v[220:223]
  v_cvt_pk_bf16_f32 v176, v176, v177
  v_cvt_pk_bf16_f32 v177, v178, v179
  v_mfma_f32_16x16x32_bf16 v[224:227], a[224:227], v[56:59], v[224:227]
  ds_write_b64 v4, v[176:177] offset:14336
  v_cvt_pk_bf16_f32 v180, v180, v181
  v_cvt_pk_bf16_f32 v181, v182, v183
  ds_write_b64 v4, v[180:181] offset:14848
  v_cvt_pk_bf16_f32 v184, v184, v185
  v_cvt_pk_bf16_f32 v185, v186, v187
  ds_write_b64 v4, v[184:185] offset:18432
  v_mfma_f32_16x16x32_bf16 v[228:231], a[224:227], v[60:63], v[228:231]
  v_mfma_f32_16x16x32_bf16 v[232:235], a[228:231], v[52:55], v[232:235]
  v_cvt_pk_bf16_f32 v188, v188, v189
  v_cvt_pk_bf16_f32 v189, v190, v191
  v_mfma_f32_16x16x32_bf16 v[236:239], a[228:231], v[56:59], v[236:239]
  ds_write_b64 v4, v[188:189] offset:18944
  v_cvt_pk_bf16_f32 v192, v192, v193
  v_cvt_pk_bf16_f32 v193, v194, v195
  ds_write_b64 v4, v[192:193] offset:19456
  v_mfma_f32_16x16x32_bf16 v[240:243], a[228:231], v[60:63], v[240:243]
  v_mfma_f32_16x16x32_bf16 v[244:247], a[232:235], v[52:55], v[244:247]
  v_cvt_pk_bf16_f32 v196, v196, v197
  v_cvt_pk_bf16_f32 v197, v198, v199
  v_mfma_f32_16x16x32_bf16 v[248:251], a[232:235], v[56:59], v[248:251]
  ds_write_b64 v4, v[196:197] offset:23040
  v_cvt_pk_bf16_f32 v200, v200, v201
  v_cvt_pk_bf16_f32 v201, v202, v203
  ds_write_b64 v4, v[200:201] offset:23552
  v_cvt_pk_bf16_f32 v204, v204, v205
  v_cvt_pk_bf16_f32 v205, v206, v207
  ds_write_b64 v4, v[204:205] offset:24064
  v_mfma_f32_16x16x32_bf16 v[252:255], a[232:235], v[60:63], v[252:255]
  s_waitcnt lgkmcnt(14)
  v_mfma_f32_16x16x32_bf16 v[112:115], a[236:239], v[52:55], v[112:115]
  v_cvt_pk_bf16_f32 v220, v220, v221
  v_cvt_pk_bf16_f32 v221, v222, v223
  v_mfma_f32_16x16x32_bf16 v[116:119], a[236:239], v[56:59], v[116:119]
  ds_write_b64 v4, v[220:221] offset:15360
  v_cvt_pk_bf16_f32 v224, v224, v225
  v_cvt_pk_bf16_f32 v225, v226, v227
  ds_write_b64 v4, v[224:225] offset:15872
  v_mfma_f32_16x16x32_bf16 v[120:123], a[236:239], v[60:63], v[120:123]
  v_mfma_f32_16x16x32_bf16 v[160:163], a[240:243], v[52:55], v[160:163]
  v_cvt_pk_bf16_f32 v228, v228, v229
  v_cvt_pk_bf16_f32 v229, v230, v231
  v_mfma_f32_16x16x32_bf16 v[164:167], a[240:243], v[56:59], v[164:167]
  ds_write_b64 v4, v[228:229] offset:16384
  v_cvt_pk_bf16_f32 v232, v232, v233
  v_cvt_pk_bf16_f32 v233, v234, v235
  ds_write_b64 v4, v[232:233] offset:19968
  v_cvt_pk_bf16_f32 v236, v236, v237
  v_cvt_pk_bf16_f32 v237, v238, v239
  ds_write_b64 v4, v[236:237] offset:20480
  v_mfma_f32_16x16x32_bf16 v[168:171], a[240:243], v[60:63], v[168:171]
  v_mfma_f32_16x16x32_bf16 v[208:211], a[244:247], v[52:55], v[208:211]
  v_cvt_pk_bf16_f32 v240, v240, v241
  v_cvt_pk_bf16_f32 v241, v242, v243
  v_mfma_f32_16x16x32_bf16 v[212:215], a[244:247], v[56:59], v[212:215]
  ds_write_b64 v4, v[240:241] offset:20992
  v_cvt_pk_bf16_f32 v244, v244, v245
  v_cvt_pk_bf16_f32 v245, v246, v247
  ds_write_b64 v4, v[244:245] offset:24576
  v_mfma_f32_16x16x32_bf16 v[216:219], a[244:247], v[60:63], v[216:219]
  v_mfma_f32_16x16x32_bf16 a[104:107], a[116:119], v[52:55], a[104:107]
  v_cvt_pk_bf16_f32 v248, v248, v249
  v_cvt_pk_bf16_f32 v249, v250, v251
  v_mfma_f32_16x16x32_bf16 a[108:111], a[116:119], v[56:59], a[108:111]
  ds_write_b64 v4, v[248:249] offset:25088
  v_cvt_pk_bf16_f32 v252, v252, v253
  v_cvt_pk_bf16_f32 v253, v254, v255
  ds_write_b64 v4, v[252:253] offset:25600
  v_mfma_f32_16x16x32_bf16 a[112:115], a[116:119], v[60:63], a[112:115]
  v_accvgpr_read_b32 v21, a104
  s_nop 1
  v_accvgpr_read_b32 v23, a108
  s_nop 3
  v_accvgpr_read_b32 v25, a112
  ds_write_b32 v6, v21 offset:0
  ds_write_b32 v6, v23 offset:256
  ds_write_b32 v6, v25 offset:512
  s_waitcnt vmcnt(8)
  v_lshlrev_b32 v88, 16, v64
  v_and_b32 v89, 0xffff0000, v64
  v_lshlrev_b32 v90, 16, v65
  v_and_b32 v91, 0xffff0000, v65
  v_lshlrev_b32 v100, 16, v66
  v_and_b32 v101, 0xffff0000, v66
  v_lshlrev_b32 v102, 16, v67
  v_and_b32 v103, 0xffff0000, v67
  s_waitcnt vmcnt(7)
  v_lshlrev_b32 v40, 16, v68
  v_and_b32 v41, 0xffff0000, v68
  v_lshlrev_b32 v42, 16, v69
  v_and_b32 v43, 0xffff0000, v69
  s_waitcnt vmcnt(6)
  v_pk_fma_f32 v[88:89], v[88:89], v[82:83], v[82:83] op_sel:[0,1,0] op_sel_hi:[1,1,0]
  v_pk_fma_f32 v[90:91], v[90:91], v[82:83], v[82:83] op_sel:[0,1,0] op_sel_hi:[1,1,0]
  v_pk_fma_f32 v[100:101], v[100:101], v[82:83], v[82:83] op_sel:[0,1,0] op_sel_hi:[1,1,0]
  v_pk_fma_f32 v[102:103], v[102:103], v[82:83], v[82:83] op_sel:[0,1,0] op_sel_hi:[1,1,0]
  v_pk_fma_f32 v[40:41], v[40:41], v[82:83], v[82:83] op_sel:[0,1,0] op_sel_hi:[1,1,0]
  v_pk_fma_f32 v[42:43], v[42:43], v[82:83], v[82:83] op_sel:[0,1,0] op_sel_hi:[1,1,0]
  s_waitcnt vmcnt(5)
  v_lshlrev_b32 v92, 16, v70
  v_and_b32 v93, 0xffff0000, v70
  v_lshlrev_b32 v94, 16, v71
  v_and_b32 v95, 0xffff0000, v71
  v_lshlrev_b32 v104, 16, v72
  v_and_b32 v105, 0xffff0000, v72
  v_lshlrev_b32 v106, 16, v73
  v_and_b32 v107, 0xffff0000, v73
  s_waitcnt vmcnt(4)
  v_lshlrev_b32 v44, 16, v74
  v_and_b32 v45, 0xffff0000, v74
  v_lshlrev_b32 v46, 16, v75
  v_and_b32 v47, 0xffff0000, v75
  s_waitcnt vmcnt(3)
  v_pk_fma_f32 v[92:93], v[92:93], v[84:85], v[84:85] op_sel:[0,1,0] op_sel_hi:[1,1,0]
  v_pk_fma_f32 v[94:95], v[94:95], v[84:85], v[84:85] op_sel:[0,1,0] op_sel_hi:[1,1,0]
  v_pk_fma_f32 v[104:105], v[104:105], v[84:85], v[84:85] op_sel:[0,1,0] op_sel_hi:[1,1,0]
  v_pk_fma_f32 v[106:107], v[106:107], v[84:85], v[84:85] op_sel:[0,1,0] op_sel_hi:[1,1,0]
  v_pk_fma_f32 v[44:45], v[44:45], v[84:85], v[84:85] op_sel:[0,1,0] op_sel_hi:[1,1,0]
  v_pk_fma_f32 v[46:47], v[46:47], v[84:85], v[84:85] op_sel:[0,1,0] op_sel_hi:[1,1,0]
  s_waitcnt vmcnt(2)
  v_lshlrev_b32 v96, 16, v76
  v_and_b32 v97, 0xffff0000, v76
  v_lshlrev_b32 v98, 16, v77
  v_and_b32 v99, 0xffff0000, v77
  v_lshlrev_b32 v108, 16, v78
  v_and_b32 v109, 0xffff0000, v78
  v_lshlrev_b32 v110, 16, v79
  v_and_b32 v111, 0xffff0000, v79
  s_waitcnt vmcnt(1)
  v_lshlrev_b32 v48, 16, v80
  v_and_b32 v49, 0xffff0000, v80
  v_lshlrev_b32 v50, 16, v81
  v_and_b32 v51, 0xffff0000, v81
  s_waitcnt vmcnt(0)
  v_pk_fma_f32 v[96:97], v[96:97], v[86:87], v[86:87] op_sel:[0,1,0] op_sel_hi:[1,1,0]
  v_pk_fma_f32 v[98:99], v[98:99], v[86:87], v[86:87] op_sel:[0,1,0] op_sel_hi:[1,1,0]
  v_pk_fma_f32 v[108:109], v[108:109], v[86:87], v[86:87] op_sel:[0,1,0] op_sel_hi:[1,1,0]
  v_pk_fma_f32 v[110:111], v[110:111], v[86:87], v[86:87] op_sel:[0,1,0] op_sel_hi:[1,1,0]
  v_pk_fma_f32 v[48:49], v[48:49], v[86:87], v[86:87] op_sel:[0,1,0] op_sel_hi:[1,1,0]
  v_pk_fma_f32 v[50:51], v[50:51], v[86:87], v[86:87] op_sel:[0,1,0] op_sel_hi:[1,1,0]
  s_waitcnt lgkmcnt(0)
  s_barrier
  ds_read_b128 v[52:55], v5 offset:0
  ds_read_b128 v[56:59], v5 offset:256
  ds_read_b128 v[60:63], v5 offset:512
  ds_read_b64 a[200:201], v7 offset:12288
  ds_read_b64 a[202:203], v8 offset:16896
  ds_read_b64 a[204:205], v9 offset:21504
  ds_read_b64 a[206:207], v7 offset:13824
  ds_read_b64 a[208:209], v8 offset:18432
  ds_read_b64 a[210:211], v9 offset:23040
  ds_read_b64 a[212:213], v7 offset:15360
  ds_read_b64 a[214:215], v8 offset:19968
  ds_read_b64 a[216:217], v9 offset:24576
  s_waitcnt lgkmcnt(7)
  v_mfma_f32_16x16x32_bf16 v[112:115], a[122:125], a[200:203], v[112:115]
  v_add_f32 v52, v52, v53
  v_add_f32 v54, v54, v55
  v_add_f32 v56, v56, v57
  v_add_f32 v58, v58, v59
  v_add_f32 v60, v60, v61
  v_add_f32 v62, v62, v63
  s_waitcnt lgkmcnt(4)
  v_mfma_f32_16x16x32_bf16 v[160:163], a[122:125], a[206:209], v[160:163]
  v_add_f32 v52, v52, v54
  v_add_f32 v56, v56, v58
  v_add_f32 v60, v60, v62
  v_add_f32 v53, v52, v56
  s_mov_b32 s27, 1904214016
  ds_read_b64 a[218:219], v7 offset:12800
  s_waitcnt lgkmcnt(2)
  v_mfma_f32_16x16x32_bf16 v[208:211], a[122:125], a[212:215], v[208:211]
  v_add_f32 v53, v53, v60
  v_cmp_nge_f32 vcc, s27, v53
  v_rcp_f32 v20, v52
  v_rcp_f32 v22, v56
  v_rcp_f32 v24, v60
  ds_read_b64 a[220:221], v8 offset:17408
  ds_read_b64 a[222:223], v9 offset:22016
  v_mfma_f32_16x16x16_bf16 v[112:115], a[122:123], a[204:205], v[112:115]
  ds_read_b64 a[224:225], v7 offset:14336
  ds_read_b64 a[226:227], v8 offset:18944
  v_mfma_f32_16x16x16_bf16 v[160:163], a[122:123], a[210:211], v[160:163]
  ds_read_b64 a[228:229], v9 offset:23552
  ds_read_b64 a[230:231], v7 offset:15872
  s_waitcnt lgkmcnt(7)
  v_mfma_f32_16x16x16_bf16 v[208:211], a[122:123], a[216:217], v[208:211]
  ds_read_b64 a[232:233], v8 offset:20480
  ds_read_b64 a[234:235], v9 offset:25088
  s_cmp_eq_u32 s35, 0
  s_cselect_b64 s[46:47], vcc, 0
  s_cmp_lg_u64 s[46:47], 0
  s_cbranch_scc1 LB_safe
  s_waitcnt lgkmcnt(7)
  v_mfma_f32_16x16x32_bf16 v[116:119], a[122:125], a[218:221], v[116:119]
  ds_read_b64 a[236:237], v7 offset:13312
  ds_read_b64 a[238:239], v8 offset:17920
  v_pk_mul_f32 v[112:113], v[112:113], v[20:21] op_sel_hi:[1,0]
  v_pk_mul_f32 v[114:115], v[114:115], v[20:21] op_sel_hi:[1,0]
  s_waitcnt lgkmcnt(6)
  v_mfma_f32_16x16x32_bf16 v[164:167], a[122:125], a[224:227], v[164:167]
  ds_read_b64 a[240:241], v9 offset:22528
  ds_read_b64 a[242:243], v7 offset:14848
  v_pk_mul_f32 v[160:161], v[160:161], v[20:21] op_sel_hi:[1,0]
  v_pk_mul_f32 v[162:163], v[162:163], v[20:21] op_sel_hi:[1,0]
  s_waitcnt lgkmcnt(5)
  v_mfma_f32_16x16x32_bf16 v[212:215], a[122:125], a[230:233], v[212:215]
  ds_read_b64 a[244:245], v8 offset:19456
  ds_read_b64 a[246:247], v9 offset:24064
  v_pk_mul_f32 v[208:209], v[208:209], v[20:21] op_sel_hi:[1,0]
  v_pk_mul_f32 v[210:211], v[210:211], v[20:21] op_sel_hi:[1,0]
  v_mfma_f32_16x16x16_bf16 v[116:119], a[122:123], a[222:223], v[116:119]
  v_cvt_pk_bf16_f32 v112, v112, v113
  v_cvt_pk_bf16_f32 v113, v114, v115
  ds_write_b64 v27, v[112:113] offset:0
  v_mfma_f32_16x16x16_bf16 v[164:167], a[122:123], a[228:229], v[164:167]
  v_cvt_pk_bf16_f32 v160, v160, v161
  v_cvt_pk_bf16_f32 v161, v162, v163
  ds_write_b64 v27, v[160:161] offset:2048
  s_waitcnt lgkmcnt(8)
  v_mfma_f32_16x16x16_bf16 v[212:215], a[122:123], a[234:235], v[212:215]
  v_cvt_pk_bf16_f32 v208, v208, v209
  v_cvt_pk_bf16_f32 v209, v210, v211
  ds_write_b64 v27, v[208:209] offset:4096
  s_waitcnt lgkmcnt(7)
  v_mfma_f32_16x16x32_bf16 v[120:123], a[122:125], a[236:239], v[120:123]
  ds_read_b64 a[248:249], v7 offset:16384
  ds_read_b64 a[250:251], v8 offset:20992
  v_pk_mul_f32 v[116:117], v[116:117], v[22:23] op_sel_hi:[1,0]
  v_pk_mul_f32 v[118:119], v[118:119], v[22:23] op_sel_hi:[1,0]
  s_waitcnt lgkmcnt(6)
  v_mfma_f32_16x16x32_bf16 v[168:171], a[122:125], a[242:245], v[168:171]
  ds_read_b64 a[252:253], v9 offset:25600
  v_pk_mul_f32 v[164:165], v[164:165], v[22:23] op_sel_hi:[1,0]
  v_pk_mul_f32 v[166:167], v[166:167], v[22:23] op_sel_hi:[1,0]
  s_waitcnt lgkmcnt(1)
  v_mfma_f32_16x16x32_bf16 v[216:219], a[122:125], a[248:251], v[216:219]
  v_pk_mul_f32 v[212:213], v[212:213], v[22:23] op_sel_hi:[1,0]
  v_pk_mul_f32 v[214:215], v[214:215], v[22:23] op_sel_hi:[1,0]
  v_mfma_f32_16x16x16_bf16 v[120:123], a[122:123], a[240:241], v[120:123]
  v_cvt_pk_bf16_f32 v116, v116, v117
  v_cvt_pk_bf16_f32 v117, v118, v119
  ds_write_b64 v27, v[116:117] offset:6144
  v_mfma_f32_16x16x16_bf16 v[168:171], a[122:123], a[246:247], v[168:171]
  v_cvt_pk_bf16_f32 v164, v164, v165
  v_cvt_pk_bf16_f32 v165, v166, v167
  ds_write_b64 v27, v[164:165] offset:8192
  s_waitcnt lgkmcnt(2)
  v_mfma_f32_16x16x16_bf16 v[216:219], a[122:123], a[252:253], v[216:219]
  v_cvt_pk_bf16_f32 v212, v212, v213
  v_cvt_pk_bf16_f32 v213, v214, v215
  ds_write_b64 v27, v[212:213] offset:10240
  v_pk_mul_f32 v[120:121], v[120:121], v[24:25] op_sel_hi:[1,0]
  v_pk_mul_f32 v[122:123], v[122:123], v[24:25] op_sel_hi:[1,0]
  v_pk_mul_f32 v[168:169], v[168:169], v[24:25] op_sel_hi:[1,0]
  v_pk_mul_f32 v[170:171], v[170:171], v[24:25] op_sel_hi:[1,0]
  s_nop 0
  v_pk_mul_f32 v[216:217], v[216:217], v[24:25] op_sel_hi:[1,0]
  v_pk_mul_f32 v[218:219], v[218:219], v[24:25] op_sel_hi:[1,0]
  v_cvt_pk_bf16_f32 v120, v120, v121
  v_cvt_pk_bf16_f32 v121, v122, v123
  ds_write_b64 v27, v[120:121] offset:36864
  v_cvt_pk_bf16_f32 v168, v168, v169
  v_cvt_pk_bf16_f32 v169, v170, v171
  ds_write_b64 v27, v[168:169] offset:38912
  v_cvt_pk_bf16_f32 v216, v216, v217
  v_cvt_pk_bf16_f32 v217, v218, v219
  ds_write_b64 v27, v[216:217] offset:40960
  s_movk_i32 s27, 6144
  s_movk_i32 s28, 12288
  s_waitcnt lgkmcnt(0)
  s_barrier
  ds_read_b128 a[0:3], v16 offset:0
  ds_read_b128 a[4:7], v16 offset:1024
  ds_read_b128 a[8:11], v16 offset:2048
  ds_read_b128 a[12:15], v16 offset:3072
  ds_read_b128 a[16:19], v16 offset:4096
  ds_read_b128 a[20:23], v16 offset:5120
  s_waitcnt lgkmcnt(5)
  v_mfma_f32_16x16x32_bf16 v[88:91], a[128:131], a[0:3], v[88:91]
  ds_read_b128 a[24:27], v16 offset:6144
  v_mfma_f32_16x16x32_bf16 v[100:103], a[152:155], a[0:3], v[100:103]
  v_mfma_f32_16x16x32_bf16 v[40:43], a[176:179], a[0:3], v[40:43]
  s_waitcnt lgkmcnt(5)
  v_mfma_f32_16x16x32_bf16 v[88:91], a[132:135], a[4:7], v[88:91]
  ds_read_b128 a[28:31], v16 offset:7168
  v_mfma_f32_16x16x32_bf16 v[100:103], a[156:159], a[4:7], v[100:103]
  v_mfma_f32_16x16x32_bf16 v[40:43], a[180:183], a[4:7], v[40:43]
  s_waitcnt lgkmcnt(5)
  v_mfma_f32_16x16x32_bf16 v[88:91], a[136:139], a[8:11], v[88:91]
  ds_read_b128 a[32:35], v16 offset:8192
  v_mfma_f32_16x16x32_bf16 v[100:103], a[160:163], a[8:11], v[100:103]
  v_mfma_f32_16x16x32_bf16 v[40:43], a[184:187], a[8:11], v[40:43]
  s_waitcnt lgkmcnt(5)
  v_mfma_f32_16x16x32_bf16 v[88:91], a[140:143], a[12:15], v[88:91]
  ds_read_b128 a[36:39], v16 offset:9216
  v_mfma_f32_16x16x32_bf16 v[100:103], a[164:167], a[12:15], v[100:103]
  v_mfma_f32_16x16x32_bf16 v[40:43], a[188:191], a[12:15], v[40:43]
  s_waitcnt lgkmcnt(5)
  v_mfma_f32_16x16x32_bf16 v[88:91], a[144:147], a[16:19], v[88:91]
  ds_read_b128 a[40:43], v16 offset:10240
  v_mfma_f32_16x16x32_bf16 v[100:103], a[168:171], a[16:19], v[100:103]
  v_mfma_f32_16x16x32_bf16 v[40:43], a[192:195], a[16:19], v[40:43]
  s_waitcnt lgkmcnt(5)
  v_mfma_f32_16x16x32_bf16 v[88:91], a[148:151], a[20:23], v[88:91]
  ds_read_b128 a[44:47], v16 offset:11264
  v_mfma_f32_16x16x32_bf16 v[100:103], a[172:175], a[20:23], v[100:103]
  v_mfma_f32_16x16x32_bf16 v[40:43], a[196:199], a[20:23], v[40:43]
  s_waitcnt lgkmcnt(5)
  v_mfma_f32_16x16x32_bf16 v[92:95], a[128:131], a[24:27], v[92:95]
  ds_read_b128 a[48:51], v16 offset:36864
  v_mfma_f32_16x16x32_bf16 v[104:107], a[152:155], a[24:27], v[104:107]
  v_mfma_f32_16x16x32_bf16 v[44:47], a[176:179], a[24:27], v[44:47]
  s_waitcnt lgkmcnt(5)
  v_mfma_f32_16x16x32_bf16 v[92:95], a[132:135], a[28:31], v[92:95]
  ds_read_b128 a[52:55], v16 offset:37888
  v_mfma_f32_16x16x32_bf16 v[104:107], a[156:159], a[28:31], v[104:107]
  v_mfma_f32_16x16x32_bf16 v[44:47], a[180:183], a[28:31], v[44:47]
  v_cvt_pk_bf16_f32 v64, v88, v89
  s_waitcnt lgkmcnt(5)
  v_mfma_f32_16x16x32_bf16 v[92:95], a[136:139], a[32:35], v[92:95]
  ds_read_b128 a[56:59], v16 offset:38912
  v_cvt_pk_bf16_f32 v65, v90, v91
  v_mfma_f32_16x16x32_bf16 v[104:107], a[160:163], a[32:35], v[104:107]
  v_cvt_pk_bf16_f32 v66, v100, v101
  v_mfma_f32_16x16x32_bf16 v[44:47], a[184:187], a[32:35], v[44:47]
  v_cvt_pk_bf16_f32 v67, v102, v103
  s_waitcnt lgkmcnt(5)
  v_mfma_f32_16x16x32_bf16 v[92:95], a[140:143], a[36:39], v[92:95]
  ds_read_b128 a[60:63], v16 offset:39936
  v_cvt_pk_bf16_f32 v68, v40, v41
  v_mfma_f32_16x16x32_bf16 v[104:107], a[164:167], a[36:39], v[104:107]
  v_cvt_pk_bf16_f32 v69, v42, v43
  v_mfma_f32_16x16x32_bf16 v[44:47], a[188:191], a[36:39], v[44:47]
  buffer_store_dwordx4 v[64:67], v26, s[16:19], 0 offen
  s_waitcnt lgkmcnt(5)
  v_mfma_f32_16x16x32_bf16 v[92:95], a[144:147], a[40:43], v[92:95]
  ds_read_b128 a[64:67], v16 offset:40960
  buffer_store_dwordx2 v[68:69], v19, s[16:19], 0 offen offset:64
  v_mfma_f32_16x16x32_bf16 v[104:107], a[168:171], a[40:43], v[104:107]
  v_mfma_f32_16x16x32_bf16 v[44:47], a[192:195], a[40:43], v[44:47]
  s_waitcnt lgkmcnt(5)
  v_mfma_f32_16x16x32_bf16 v[92:95], a[148:151], a[44:47], v[92:95]
  ds_read_b128 a[68:71], v16 offset:41984
  v_mfma_f32_16x16x32_bf16 v[104:107], a[172:175], a[44:47], v[104:107]
  v_mfma_f32_16x16x32_bf16 v[44:47], a[196:199], a[44:47], v[44:47]
  s_waitcnt lgkmcnt(5)
  v_mfma_f32_16x16x32_bf16 v[96:99], a[128:131], a[48:51], v[96:99]
  v_mfma_f32_16x16x32_bf16 v[108:111], a[152:155], a[48:51], v[108:111]
  v_mfma_f32_16x16x32_bf16 v[48:51], a[176:179], a[48:51], v[48:51]
  s_waitcnt lgkmcnt(4)
  v_mfma_f32_16x16x32_bf16 v[96:99], a[132:135], a[52:55], v[96:99]
  v_mfma_f32_16x16x32_bf16 v[108:111], a[156:159], a[52:55], v[108:111]
  v_mfma_f32_16x16x32_bf16 v[48:51], a[180:183], a[52:55], v[48:51]
  v_cvt_pk_bf16_f32 v70, v92, v93
  s_waitcnt lgkmcnt(3)
  v_mfma_f32_16x16x32_bf16 v[96:99], a[136:139], a[56:59], v[96:99]
  v_cvt_pk_bf16_f32 v71, v94, v95
  v_mfma_f32_16x16x32_bf16 v[108:111], a[160:163], a[56:59], v[108:111]
  v_cvt_pk_bf16_f32 v72, v104, v105
  v_mfma_f32_16x16x32_bf16 v[48:51], a[184:187], a[56:59], v[48:51]
  v_cvt_pk_bf16_f32 v73, v106, v107
  s_waitcnt lgkmcnt(2)
  v_mfma_f32_16x16x32_bf16 v[96:99], a[140:143], a[60:63], v[96:99]
  v_cvt_pk_bf16_f32 v74, v44, v45
  v_mfma_f32_16x16x32_bf16 v[108:111], a[164:167], a[60:63], v[108:111]
  v_cvt_pk_bf16_f32 v75, v46, v47
  v_mfma_f32_16x16x32_bf16 v[48:51], a[188:191], a[60:63], v[48:51]
  buffer_store_dwordx4 v[70:73], v26, s[16:19], s27 offen
  s_waitcnt lgkmcnt(1)
  v_mfma_f32_16x16x32_bf16 v[96:99], a[144:147], a[64:67], v[96:99]
  buffer_store_dwordx2 v[74:75], v19, s[16:19], s27 offen offset:64
  v_mfma_f32_16x16x32_bf16 v[108:111], a[168:171], a[64:67], v[108:111]
  v_mfma_f32_16x16x32_bf16 v[48:51], a[192:195], a[64:67], v[48:51]
  s_waitcnt lgkmcnt(0)
  v_mfma_f32_16x16x32_bf16 v[96:99], a[148:151], a[68:71], v[96:99]
  v_mfma_f32_16x16x32_bf16 v[108:111], a[172:175], a[68:71], v[108:111]
  v_mfma_f32_16x16x32_bf16 v[48:51], a[196:199], a[68:71], v[48:51]
  s_nop 5
  v_cvt_pk_bf16_f32 v76, v96, v97
  v_cvt_pk_bf16_f32 v77, v98, v99
  v_cvt_pk_bf16_f32 v78, v108, v109
  v_cvt_pk_bf16_f32 v79, v110, v111
  v_cvt_pk_bf16_f32 v80, v48, v49
  v_cvt_pk_bf16_f32 v81, v50, v51
  buffer_store_dwordx4 v[76:79], v26, s[16:19], s28 offen
  buffer_store_dwordx2 v[80:81], v19, s[16:19], s28 offen offset:64
  s_endpgm
LB_safe:
  s_waitcnt vmcnt(0) lgkmcnt(0)
  s_barrier
  v_subrev_u32 v4, s30, v10
  v_subrev_u32 v5, s30, v11
  v_mov_b32 v6, 0
  v_mov_b32 v7, 0
  v_mov_b32 v8, 0
  s_mov_b32 s44, 0
LB_mx:
  s_lshr_b32 s27, s44, 1
  s_mul_i32 s27, s27, 12288
  s_and_b32 s28, s44, 1
  s_lshl_b32 s28, s28, 11
  s_add_u32 s27, s27, s28
  s_add_u32 s27, s27, s34
  s_add_u32 s28, s27, 4096
  s_add_u32 s29, s27, 8192
  buffer_load_dwordx4 v[112:115], v4, s[20:23], s27 offen
  buffer_load_dwordx4 v[116:119], v5, s[20:23], s27 offen
  buffer_load_dwordx4 v[120:123], v4, s[20:23], s28 offen
  buffer_load_dwordx4 v[124:127], v5, s[20:23], s28 offen
  buffer_load_dwordx4 v[128:131], v4, s[20:23], s29 offen
  buffer_load_dwordx4 v[132:135], v5, s[20:23], s29 offen
  s_waitcnt vmcnt(5)
  v_mfma_f32_16x16x32_bf16 v[64:67], v[112:115], a[0:3], v[28:31]
  v_mfma_f32_16x16x32_bf16 v[68:71], v[112:115], a[24:27], v[32:35]
  v_mfma_f32_16x16x32_bf16 v[72:75], v[112:115], a[48:51], v[36:39]
  s_waitcnt vmcnt(4)
  v_mfma_f32_16x16x32_bf16 v[64:67], v[116:119], a[4:7], v[64:67]
  v_mfma_f32_16x16x32_bf16 v[68:71], v[116:119], a[28:31], v[68:71]
  v_mfma_f32_16x16x32_bf16 v[72:75], v[116:119], a[52:55], v[72:75]
  s_waitcnt vmcnt(3)
  v_mfma_f32_16x16x32_bf16 v[64:67], v[120:123], a[8:11], v[64:67]
  v_mfma_f32_16x16x32_bf16 v[68:71], v[120:123], a[32:35], v[68:71]
  v_mfma_f32_16x16x32_bf16 v[72:75], v[120:123], a[56:59], v[72:75]
  s_waitcnt vmcnt(2)
  v_mfma_f32_16x16x32_bf16 v[64:67], v[124:127], a[12:15], v[64:67]
  v_mfma_f32_16x16x32_bf16 v[68:71], v[124:127], a[36:39], v[68:71]
  v_mfma_f32_16x16x32_bf16 v[72:75], v[124:127], a[60:63], v[72:75]
  s_waitcnt vmcnt(1)
  v_mfma_f32_16x16x32_bf16 v[64:67], v[128:131], a[16:19], v[64:67]
  v_mfma_f32_16x16x32_bf16 v[68:71], v[128:131], a[40:43], v[68:71]
  v_mfma_f32_16x16x32_bf16 v[72:75], v[128:131], a[64:67], v[72:75]
  s_waitcnt vmcnt(0)
  v_mfma_f32_16x16x32_bf16 v[64:67], v[132:135], a[20:23], v[64:67]
  v_mfma_f32_16x16x32_bf16 v[68:71], v[132:135], a[44:47], v[68:71]
  v_mfma_f32_16x16x32_bf16 v[72:75], v[132:135], a[68:71], v[72:75]
  s_nop 5
  v_max3_f32 v6, v6, v64, v65
  v_max3_f32 v6, v6, v66, v67
  v_max3_f32 v7, v7, v68, v69
  v_max3_f32 v7, v7, v70, v71
  v_max3_f32 v8, v8, v72, v73
  v_max3_f32 v8, v8, v74, v75
  s_add_u32 s44, s44, 1
  s_cmp_lt_u32 s44, 20
  s_nop 7
  s_cbranch_scc1 LB_mx
  v_mov_b32 v64, v6
  v_mov_b32 v65, v7
  v_mov_b32 v66, v8
  v_permlane16_swap_b32 v6, v64
  v_permlane16_swap_b32 v7, v65
  v_permlane16_swap_b32 v8, v66
  v_max_f32 v6, v6, v64
  v_mov_b32 v64, v6
  v_max_f32 v7, v7, v65
  v_mov_b32 v65, v7
  v_max_f32 v8, v8, v66
  v_mov_b32 v66, v8
  v_permlane32_swap_b32 v6, v64
  v_permlane32_swap_b32 v7, v65
  v_permlane32_swap_b32 v8, v66
  v_max_f32 v6, v6, v64
  v_max_f32 v7, v7, v65
  v_max_f32 v8, v8, v66
  v_lshlrev_b32 v67, 4, v3
  s_lshl_b32 s27, s24, 2
  s_add_u32 s27, s27, 161792
  v_add_u32 v68, s27, v67
  v_add_u32 v67, 161792, v67
  ds_write_b32 v68, v6 offset:0
  ds_write_b32 v68, v7 offset:256
  ds_write_b32 v68, v8 offset:512
  s_waitcnt lgkmcnt(0)
  s_barrier
  ds_read_b128 v[72:75], v67 offset:0
  ds_read_b128 v[76:79], v67 offset:256
  ds_read_b128 v[80:83], v67 offset:512
  s_waitcnt lgkmcnt(2)
  v_max3_f32 v72, v72, v73, v74
  v_max_f32 v72, v72, v75
  v_sub_f32 v28, v28, v72
  v_sub_f32 v29, v29, v72
  v_sub_f32 v30, v30, v72
  v_sub_f32 v31, v31, v72
  s_waitcnt lgkmcnt(1)
  v_max3_f32 v76, v76, v77, v78
  v_max_f32 v76, v76, v79
  v_sub_f32 v32, v32, v76
  v_sub_f32 v33, v33, v76
  v_sub_f32 v34, v34, v76
  v_sub_f32 v35, v35, v76
  s_waitcnt lgkmcnt(0)
  v_max3_f32 v80, v80, v81, v82
  v_max_f32 v80, v80, v83
  v_sub_f32 v36, v36, v80
  v_sub_f32 v37, v37, v80
  v_sub_f32 v38, v38, v80
  v_sub_f32 v39, v39, v80
  v_add_u32 v4, 153600, v4
  v_add_u32 v5, 153600, v5
  ds_read_b128 v[112:115], v4 offset:0
  ds_read_b128 v[116:119], v5 offset:0
  ds_read_b128 v[120:123], v4 offset:2048
  ds_read_b128 v[124:127], v5 offset:2048
  ds_read_b128 v[128:131], v4 offset:4096
  ds_read_b128 v[132:135], v5 offset:4096
  s_waitcnt lgkmcnt(5)
  v_mfma_f32_16x16x32_bf16 v[88:91], v[112:115], a[0:3], 0
  v_mfma_f32_16x16x32_bf16 v[92:95], v[112:115], a[24:27], 0
  v_mfma_f32_16x16x32_bf16 v[96:99], v[112:115], a[48:51], 0
  s_waitcnt lgkmcnt(4)
  v_mfma_f32_16x16x32_bf16 v[88:91], v[116:119], a[4:7], v[88:91]
  v_mfma_f32_16x16x32_bf16 v[92:95], v[116:119], a[28:31], v[92:95]
  v_mfma_f32_16x16x32_bf16 v[96:99], v[116:119], a[52:55], v[96:99]
  s_waitcnt lgkmcnt(3)
  v_mfma_f32_16x16x32_bf16 v[88:91], v[120:123], a[8:11], v[88:91]
  v_mfma_f32_16x16x32_bf16 v[92:95], v[120:123], a[32:35], v[92:95]
  v_mfma_f32_16x16x32_bf16 v[96:99], v[120:123], a[56:59], v[96:99]
  s_waitcnt lgkmcnt(2)
  v_mfma_f32_16x16x32_bf16 v[88:91], v[124:127], a[12:15], v[88:91]
  v_mfma_f32_16x16x32_bf16 v[92:95], v[124:127], a[36:39], v[92:95]
  v_mfma_f32_16x16x32_bf16 v[96:99], v[124:127], a[60:63], v[96:99]
  s_waitcnt lgkmcnt(1)
  v_mfma_f32_16x16x32_bf16 v[88:91], v[128:131], a[16:19], v[88:91]
  v_mfma_f32_16x16x32_bf16 v[92:95], v[128:131], a[40:43], v[92:95]
  v_mfma_f32_16x16x32_bf16 v[96:99], v[128:131], a[64:67], v[96:99]
  s_waitcnt lgkmcnt(0)
  v_mfma_f32_16x16x32_bf16 v[88:91], v[132:135], a[20:23], v[88:91]
  v_mfma_f32_16x16x32_bf16 v[92:95], v[132:135], a[44:47], v[92:95]
  v_mfma_f32_16x16x32_bf16 v[96:99], v[132:135], a[68:71], v[96:99]
  s_mov_b32 s31, s43
  s_add_u32 m0, s30, 0
  s_nop 0
  buffer_load_dwordx4 v16, s[20:23], s31 offen offset:0 lds
  buffer_load_dwordx4 v16, s[20:23], s31 offen offset:1024 lds
  buffer_load_dwordx4 v16, s[20:23], s31 offen offset:2048 lds
  buffer_load_dwordx4 v16, s[20:23], s31 offen offset:3072 lds
  s_add_u32 m0, s30, 4096
  s_nop 0
  buffer_load_dwordx4 v17, s[20:23], s31 offen offset:0 lds
  buffer_load_dwordx4 v17, s[20:23], s31 offen offset:1024 lds
  buffer_load_dwordx4 v17, s[20:23], s31 offen offset:2048 lds
  buffer_load_dwordx4 v17, s[20:23], s31 offen offset:3072 lds
  s_add_u32 m0, s30, 8192
  s_nop 0
  buffer_load_dwordx4 v18, s[20:23], s31 offen offset:0 lds
  buffer_load_dwordx4 v18, s[20:23], s31 offen offset:1024 lds
  buffer_load_dwordx4 v18, s[20:23], s31 offen offset:2048 lds
  s_mov_b32 s35, 1
  s_waitcnt vmcnt(0) lgkmcnt(0)
  s_barrier
  s_nop 15
  s_branch LB_pre
LB_end:
  s_endpgm
.section .rodata,"a"
.p2align 6
.amdhsa_kernel standalone__video_timesformer__vision_kernel
  .amdhsa_next_free_vgpr 512
  .amdhsa_next_free_sgpr 96
  .amdhsa_accum_offset 256
  .amdhsa_group_segment_fixed_size 0
  .amdhsa_kernarg_size 64
  .amdhsa_user_sgpr_count 2
  .amdhsa_user_sgpr_kernarg_segment_ptr 1
  .amdhsa_system_sgpr_workgroup_id_x 1
.end_amdhsa_kernel
.p2align 6
.amdhsa_kernel standalone__video_timesformer__vision_b_kernel
  .amdhsa_next_free_vgpr 512
  .amdhsa_next_free_sgpr 96
  .amdhsa_accum_offset 256
  .amdhsa_group_segment_fixed_size 0
  .amdhsa_kernarg_size 64
  .amdhsa_user_sgpr_count 2
  .amdhsa_user_sgpr_kernarg_segment_ptr 1
  .amdhsa_system_sgpr_workgroup_id_x 1
.end_amdhsa_kernel
```
